```python
import torch

def _softmax(x, axis=-1):
    return torch.softmax(x, dim=axis)
def _gelu(x):
    return torch.nn.functional.gelu(x, approximate="tanh")
def _silu(x):
    return torch.nn.functional.silu(x)
def _sigmoid(x):
    return torch.sigmoid(x)
def _layernorm(x, axis=-1, eps=1e-5):
    m = x.mean(dim=axis, keepdim=True)
    v = x.var(dim=axis, keepdim=True, unbiased=False)
    return (x - m) / torch.sqrt(v + eps)
def _scatter_add(tgt, idx, src, axis=0):
    return tgt.clone().index_add_(axis, idx, src)
def _segment_sum(src, seg, n):
    out = torch.zeros((n,) + src.shape[1:], dtype=src.dtype)
    return out.index_add_(0, seg, src)
def _pad(x, pw):
    flat = tuple(v for pair in reversed(pw) for v in pair)
    return torch.nn.functional.pad(x, flat)

kernel_name = 'recurrent_scan__mha_block_cached__moe_arch_mod__decode'

def setup_inputs():

    _w = (lambda a: (lambda t: t.to(torch.bfloat16) if t.is_floating_point() else t)(torch.as_tensor(a)))
    def _A_setup():
        B, Sq, D = 2, 1, 640
        H, Sk, Dh = 32, 8192, 192
        return {
            "x": _w((lambda *s: torch.randn(*s, dtype=torch.bfloat16) * 0.05)(B, Sq, D)),
            "k_cache": _w((lambda *s: torch.randn(*s, dtype=torch.bfloat16) * 1.6)(B, H, Sk, Dh)),
            "v_cache": _w((lambda *s: torch.randn(*s, dtype=torch.bfloat16) * 0.2)(B, H, Sk, Dh)),
            "wq": _w((lambda *s: torch.randn(*s, dtype=torch.bfloat16) * 1.6)(D, H * Dh) * (D ** -0.5)),
            "wo": _w((lambda *s: torch.randn(*s, dtype=torch.bfloat16) * 0.2)(H * Dh, D) * ((H * Dh) ** -0.5)),
        }
    _A_in = _A_setup()

    def _B_setup():
        B, S, D, F, C = 2, 1, 640, 1536, 1
        return {
            "x": _w((lambda *s: torch.randn(*s, dtype=torch.bfloat16) * 0.05)(B, S, D)),
            "w_r": _w((lambda *s: torch.randn(*s, dtype=torch.bfloat16) * 0.1)(D)),
            "w_gate": _w((lambda *s: torch.randn(*s, dtype=torch.bfloat16) * 0.1)(D, F)),
            "w_up": _w((lambda *s: torch.randn(*s, dtype=torch.bfloat16) * 0.1)(D, F)),
            "w_down": _w((lambda *s: torch.randn(*s, dtype=torch.bfloat16) * 0.1)(F, D)),
        }
    _B_in = _B_setup()

    return {
        "A_x": _A_in["x"],
        "A_k_cache": _A_in["k_cache"],
        "A_v_cache": _A_in["v_cache"],
        "A_wq": _A_in["wq"],
        "A_wo": _A_in["wo"],
        "B_x": _B_in["x"],
        "B_w_r": _B_in["w_r"],
        "B_w_gate": _B_in["w_gate"],
        "B_w_up": _B_in["w_up"],
        "B_w_down": _B_in["w_down"],
    }

def reference(A_x, A_k_cache, A_v_cache, A_wq, A_wo, B_x, B_w_r, B_w_gate, B_w_up, B_w_down):
    def _A_ref(x, k_cache, v_cache, wq, wo):
        B, Sq, D = x.shape
        H, Dh = 32, 192
        q = (lambda x, *d: x.permute(*d))((x @ wq).reshape(B, Sq, H, Dh), 0, 2, 1, 3)
        scores = torch.einsum("bhqd,bhkd->bhqk", q, k_cache) * (Dh ** -0.5)
        p = _softmax(scores, axis=-1)
        o = torch.einsum("bhqk,bhkd->bhqd", p, v_cache)
        return (lambda x, *d: x.permute(*d))(o, 0, 2, 1, 3).reshape(B, Sq, H * Dh) @ wo

    def _B_ref(x, w_r, w_gate, w_up, w_down):
        B, S, D = x.shape
        C = 1
        r = x @ w_r
        idx = torch.argsort(-r, axis=-1)[:, :C]
        idx_e = (lambda x, n, axis: torch.repeat_interleave(x, n, dim=axis))(idx.reshape(B, C, 1), D, axis=2)
        x_sel = (lambda x, i, axis: torch.take_along_dim(x, i, dim=axis))(x, idx_e, axis=1)
        g = _silu(x_sel @ w_gate)
        u = x_sel @ w_up
        y = (g * u) @ w_down
        r_sel = _sigmoid((lambda x, i, axis: torch.take_along_dim(x, i, dim=axis))(r, idx, axis=1))
        y = y * r_sel.reshape(B, C, 1)
        b_off = (torch.arange(B) * S).reshape(B, 1)
        flat_idx = (idx + b_off).reshape(B * C)
        zero = (x * 0.0).reshape(B * S, D)
        upd = _scatter_add(zero, flat_idx, y.reshape(B * C, D), axis=0)
        return x + upd.reshape(B, S, D)

    x = A_x
    xn = _layernorm(x, axis=-1)
    s = _A_ref(xn, A_k_cache, A_v_cache, A_wq, A_wo)
    g = _silu(_B_ref(xn, B_w_r, B_w_gate, B_w_up, B_w_down))
    return x + s * g
```

```asm
; @launch grid=(256,1,1) block=(512,1,1) lds=62272
.amdgcn_target "amdgcn-amd-amdhsa--gfx950"
.text
.globl recurrent_scan__mha_block_cached__moe_arch_mod__decode_kernel
.p2align 8
.type recurrent_scan__mha_block_cached__moe_arch_mod__decode_kernel,@function
recurrent_scan__mha_block_cached__moe_arch_mod__decode_kernel:
    s_cmp_ge_u32 s2, 256
    s_cbranch_scc1 L_end
    s_load_dwordx16 s[16:31], s[0:1], 0
    s_load_dwordx8 s[32:39], s[0:1], 64
    s_load_dwordx2 s[40:41], s[0:1], 96
    v_lshrrev_b32 v1, 6, v0
    v_and_b32 v0, 63, v0
    v_readfirstlane_b32 s3, v1
    s_and_b32 s9, s2, 7
    s_lshr_b32 s10, s2, 3
    s_lshl_b32 s4, s9, 2
    s_lshr_b32 s11, s10, 3
    s_add_u32 s4, s4, s11
    s_bfe_u32 s5, s10, 0x10002
    s_and_b32 s6, s10, 3
    s_lshl_b32 s8, s5, 5
    s_add_u32 s8, s8, s4
    s_lshl_b32 s7, s8, 2
    s_add_u32 s7, s7, s6
    s_mov_b32 s69, s3
    s_cmp_ge_u32 s3, 4
    s_cbranch_scc1 L_H
    v_lshrrev_b32 v4, 3, v0
    v_and_b32 v5, 7, v0
    v_mul_u32_u24 v1, 384, v4
    v_lshl_add_u32 v1, v5, 4, v1
    s_mul_i32 s9, s3, 3072
    s_mul_i32 s11, s6, 12288
    s_add_u32 s9, s9, s11
    s_mul_i32 s43, s8, 3145728
    s_add_u32 s64, s43, 3145728
    v_add_u32 v1, s9, v1
    s_mul_i32 s9, s8, 1
    s_and_b32 s9, s9, 63
    s_mul_i32 s9, s9, 49152
    s_add_u32 s42, s43, s9
    s_waitcnt lgkmcnt(0)
    s_mov_b32 s52, s18
    s_mov_b32 s53, s19
    s_mov_b32 s54, 201326592
    s_mov_b32 s55, 0x20000
    buffer_load_dwordx4 v[64:67], v1, s[52:55], s42 offen offset:0 nt
    buffer_load_dwordx4 v[68:71], v1, s[52:55], s42 offen offset:128 nt
    buffer_load_dwordx4 v[72:75], v1, s[52:55], s42 offen offset:256 nt
    s_add_u32 s42, s42, 49152
    s_cmp_ge_u32 s42, s64
    s_cselect_b32 s42, s43, s42
    buffer_load_dwordx4 v[76:79], v1, s[52:55], s42 offen offset:0 nt
    buffer_load_dwordx4 v[80:83], v1, s[52:55], s42 offen offset:128 nt
    buffer_load_dwordx4 v[84:87], v1, s[52:55], s42 offen offset:256 nt
    s_add_u32 s42, s42, 49152
    s_cmp_ge_u32 s42, s64
    s_cselect_b32 s42, s43, s42
    s_load_dword s78, s[40:41], 671744
    s_mov_b32 s56, s40
    s_mov_b32 s57, s41
    s_mov_b32 s58, 4194304
    s_mov_b32 s59, 0x20000
    v_and_b32 v6, 1, v0
    v_cmp_eq_u32 vcc, 1, v6
    v_mov_b32 v6, 0x0c0c0100
    v_mov_b32 v7, 0x01000c0c
    v_cndmask_b32 v6, v6, v7, vcc
    v_mov_b32 v7, 0x0c0c0302
    v_mov_b32 v8, 0x03020c0c
    v_cndmask_b32 v7, v7, v8, vcc
    v_bfe_u32 v8, v0, 1, 2
    v_cmp_eq_u32 vcc, 0, v8
    v_mov_b32 v24, 0x0c0c0c0c
    v_mov_b32 v28, 0x0c0c0c0c
    v_cndmask_b32 v24, v24, v6, vcc
    v_cndmask_b32 v28, v28, v7, vcc
    v_cmp_eq_u32 vcc, 1, v8
    v_mov_b32 v25, 0x0c0c0c0c
    v_mov_b32 v29, 0x0c0c0c0c
    v_cndmask_b32 v25, v25, v6, vcc
    v_cndmask_b32 v29, v29, v7, vcc
    v_cmp_eq_u32 vcc, 2, v8
    v_mov_b32 v26, 0x0c0c0c0c
    v_mov_b32 v30, 0x0c0c0c0c
    v_cndmask_b32 v26, v26, v6, vcc
    v_cndmask_b32 v30, v30, v7, vcc
    v_cmp_eq_u32 vcc, 3, v8
    v_mov_b32 v27, 0x0c0c0c0c
    v_mov_b32 v31, 0x0c0c0c0c
    v_cndmask_b32 v27, v27, v6, vcc
    v_cndmask_b32 v31, v31, v7, vcc
    s_mul_i32 s9, s3, 1152
    s_add_u32 s9, s9, 3072
    v_mul_u32_u24 v2, 144, v4
    v_add_u32 v2, s9, v2
    v_mov_b32 v3, v2
    v_lshrrev_b32 v6, 5, v0
    s_lshl_b32 s9, s3, 1
    v_add_u32 v6, s9, v6
    v_mul_u32_u24 v8, 416, v6
    v_lshl_add_u32 v8, v5, 3, v8
    v_bfe_u32 v6, v0, 4, 1
    v_lshl_add_u32 v8, v6, 2, v8
    v_add_u32 v8, 7680, v8
    v_lshlrev_b32 v6, 4, v5
    s_waitcnt vmcnt(3)
    buffer_load_dwordx4 v[88:91], v1, s[52:55], s42 offen offset:0 nt
    buffer_load_dwordx4 v[92:95], v1, s[52:55], s42 offen offset:128 nt
    buffer_load_dwordx4 v[96:99], v1, s[52:55], s42 offen offset:256 nt
    s_add_u32 s42, s42, 49152
    s_cmp_ge_u32 s42, s64
    s_cselect_b32 s42, s43, s42
    s_waitcnt vmcnt(3)
    buffer_load_dwordx4 v[100:103], v1, s[52:55], s42 offen offset:0 nt
    buffer_load_dwordx4 v[104:107], v1, s[52:55], s42 offen offset:128 nt
    buffer_load_dwordx4 v[108:111], v1, s[52:55], s42 offen offset:256 nt
    s_add_u32 s42, s42, 49152
    s_cmp_ge_u32 s42, s64
    s_cselect_b32 s42, s43, s42
    s_waitcnt vmcnt(3)
    buffer_load_dwordx4 v[112:115], v1, s[52:55], s42 offen offset:0 nt
    buffer_load_dwordx4 v[116:119], v1, s[52:55], s42 offen offset:128 nt
    buffer_load_dwordx4 v[120:123], v1, s[52:55], s42 offen offset:256 nt
    s_add_u32 s42, s42, 49152
    s_cmp_ge_u32 s42, s64
    s_cselect_b32 s42, s43, s42
    s_waitcnt vmcnt(3)
    buffer_load_dwordx4 v[124:127], v1, s[52:55], s42 offen offset:0 nt
    buffer_load_dwordx4 v[128:131], v1, s[52:55], s42 offen offset:128 nt
    buffer_load_dwordx4 v[132:135], v1, s[52:55], s42 offen offset:256 nt
    s_add_u32 s42, s42, 49152
    s_cmp_ge_u32 s42, s64
    s_cselect_b32 s42, s43, s42
    s_waitcnt vmcnt(3)
    buffer_load_dwordx4 v[136:139], v1, s[52:55], s42 offen offset:0 nt
    buffer_load_dwordx4 v[140:143], v1, s[52:55], s42 offen offset:128 nt
    buffer_load_dwordx4 v[144:147], v1, s[52:55], s42 offen offset:256 nt
    s_add_u32 s42, s42, 49152
    s_cmp_ge_u32 s42, s64
    s_cselect_b32 s42, s43, s42
    s_waitcnt vmcnt(3)
    buffer_load_dwordx4 v[148:151], v1, s[52:55], s42 offen offset:0 nt
    buffer_load_dwordx4 v[152:155], v1, s[52:55], s42 offen offset:128 nt
    buffer_load_dwordx4 v[156:159], v1, s[52:55], s42 offen offset:256 nt
    s_add_u32 s42, s42, 49152
    s_cmp_ge_u32 s42, s64
    s_cselect_b32 s42, s43, s42
    s_waitcnt vmcnt(3)
    buffer_load_dwordx4 v[160:163], v1, s[52:55], s42 offen offset:0 nt
    buffer_load_dwordx4 v[164:167], v1, s[52:55], s42 offen offset:128 nt
    buffer_load_dwordx4 v[168:171], v1, s[52:55], s42 offen offset:256 nt
    s_add_u32 s42, s42, 49152
    s_cmp_ge_u32 s42, s64
    s_cselect_b32 s42, s43, s42
    s_waitcnt vmcnt(3)
    buffer_load_dwordx4 v[172:175], v1, s[52:55], s42 offen offset:0 nt
    buffer_load_dwordx4 v[176:179], v1, s[52:55], s42 offen offset:128 nt
    buffer_load_dwordx4 v[180:183], v1, s[52:55], s42 offen offset:256 nt
    s_add_u32 s42, s42, 49152
    s_cmp_ge_u32 s42, s64
    s_cselect_b32 s42, s43, s42
    s_waitcnt vmcnt(3)
    buffer_load_dwordx4 v[184:187], v1, s[52:55], s42 offen offset:0 nt
    buffer_load_dwordx4 v[188:191], v1, s[52:55], s42 offen offset:128 nt
    buffer_load_dwordx4 v[192:195], v1, s[52:55], s42 offen offset:256 nt
    s_add_u32 s42, s42, 49152
    s_cmp_ge_u32 s42, s64
    s_cselect_b32 s42, s43, s42
    s_waitcnt vmcnt(3)
    buffer_load_dwordx4 v[196:199], v1, s[52:55], s42 offen offset:0 nt
    buffer_load_dwordx4 v[200:203], v1, s[52:55], s42 offen offset:128 nt
    buffer_load_dwordx4 v[204:207], v1, s[52:55], s42 offen offset:256 nt
    s_add_u32 s42, s42, 49152
    s_cmp_ge_u32 s42, s64
    s_cselect_b32 s42, s43, s42
    s_waitcnt vmcnt(3)
    buffer_load_dwordx4 v[208:211], v1, s[52:55], s42 offen offset:0 nt
    buffer_load_dwordx4 v[212:215], v1, s[52:55], s42 offen offset:128 nt
    buffer_load_dwordx4 v[216:219], v1, s[52:55], s42 offen offset:256 nt
    s_add_u32 s42, s42, 49152
    s_cmp_ge_u32 s42, s64
    s_cselect_b32 s42, s43, s42
    s_waitcnt vmcnt(3)
    buffer_load_dwordx4 v[220:223], v1, s[52:55], s42 offen offset:0 nt
    buffer_load_dwordx4 v[224:227], v1, s[52:55], s42 offen offset:128 nt
    buffer_load_dwordx4 v[228:231], v1, s[52:55], s42 offen offset:256 nt
    s_add_u32 s42, s42, 49152
    s_cmp_ge_u32 s42, s64
    s_cselect_b32 s42, s43, s42
    s_waitcnt vmcnt(3)
    buffer_load_dwordx4 v[232:235], v1, s[52:55], s42 offen offset:0 nt
    buffer_load_dwordx4 v[236:239], v1, s[52:55], s42 offen offset:128 nt
    buffer_load_dwordx4 v[240:243], v1, s[52:55], s42 offen offset:256 nt
    s_add_u32 s42, s42, 49152
    s_cmp_ge_u32 s42, s64
    s_cselect_b32 s42, s43, s42
    s_waitcnt vmcnt(3)
    buffer_load_dwordx4 v[244:247], v1, s[52:55], s42 offen offset:0 nt
    buffer_load_dwordx4 v[248:251], v1, s[52:55], s42 offen offset:128 nt
    buffer_load_dwordx4 v[252:255], v1, s[52:55], s42 offen offset:256 nt
    s_add_u32 s42, s42, 49152
    s_cmp_ge_u32 s42, s64
    s_cselect_b32 s42, s43, s42
    s_waitcnt lgkmcnt(0)
    s_lshr_b32 s9, s0, 4
    s_lshl_b32 s9, s9, 8
    s_add_u32 s78, s78, s9
    s_add_u32 s78, s78, 1
    s_mul_i32 s9, s78, 0x9e3779b1
    s_and_b32 s96, s78, 15
    s_bfe_u32 s97, s9, 0x40014
    s_bfe_u32 s98, s9, 0x40018
    s_lshr_b32 s99, s9, 28
    v_mov_b32 v11, 15
    s_barrier
    ds_read_b128 v[12:15], v6 offset:2560
    ds_read_b128 v[16:19], v6 offset:2688
    ds_read_b128 v[20:23], v6 offset:2816
    s_mov_b32 s66, 0
    s_mov_b32 s10, 1033096506
    s_waitcnt lgkmcnt(0)
    s_waitcnt vmcnt(42)
    v_dot2_f32_bf16 v9, v64, v12, 0
    v_dot2_f32_bf16 v10, v76, v12, 0
    v_dot2_f32_bf16 v9, v65, v13, v9
    v_dot2_f32_bf16 v10, v77, v13, v10
    v_dot2_f32_bf16 v9, v66, v14, v9
    v_dot2_f32_bf16 v10, v78, v14, v10
    v_dot2_f32_bf16 v9, v67, v15, v9
    v_dot2_f32_bf16 v10, v79, v15, v10
    v_dot2_f32_bf16 v9, v68, v16, v9
    v_dot2_f32_bf16 v10, v80, v16, v10
    v_dot2_f32_bf16 v9, v69, v17, v9
    v_dot2_f32_bf16 v10, v81, v17, v10
    v_dot2_f32_bf16 v9, v70, v18, v9
    v_dot2_f32_bf16 v10, v82, v18, v10
    v_dot2_f32_bf16 v9, v71, v19, v9
    v_dot2_f32_bf16 v10, v83, v19, v10
    v_dot2_f32_bf16 v9, v72, v20, v9
    v_dot2_f32_bf16 v10, v84, v20, v10
    v_dot2_f32_bf16 v9, v73, v21, v9
    v_dot2_f32_bf16 v10, v85, v21, v10
    v_dot2_f32_bf16 v9, v74, v22, v9
    v_dot2_f32_bf16 v10, v86, v22, v10
    v_dot2_f32_bf16 v9, v75, v23, v9
    v_dot2_f32_bf16 v10, v87, v23, v10
    s_nop 2
    v_add_f32_dpp v9, v9, v9 quad_perm:[1,0,3,2] row_mask:0xf bank_mask:0xf
    v_add_f32_dpp v10, v10, v10 quad_perm:[1,0,3,2] row_mask:0xf bank_mask:0xf
    s_nop 0
    v_add_f32_dpp v9, v9, v9 quad_perm:[2,3,0,1] row_mask:0xf bank_mask:0xf
    v_add_f32_dpp v10, v10, v10 quad_perm:[2,3,0,1] row_mask:0xf bank_mask:0xf
    s_nop 0
    v_add_f32_dpp v9, v9, v9 row_half_mirror row_mask:0xf bank_mask:0xf
    v_add_f32_dpp v10, v10, v10 row_half_mirror row_mask:0xf bank_mask:0xf
    v_cvt_pk_bf16_f32 v6, v9, v10
    v_lshlrev_b32 v9, 16, v6
    v_and_b32 v10, 0xffff0000, v6
    v_mul_f32 v9, s10, v9
    v_mul_f32 v10, s10, v10
    v_cvt_pk_bf16_f32 v6, v9, v10
    ds_write_b32 v2, v6 offset:0
    s_waitcnt vmcnt(6)
    buffer_load_dwordx4 v[64:67], v1, s[52:55], s42 offen offset:0 nt
    buffer_load_dwordx4 v[68:71], v1, s[52:55], s42 offen offset:128 nt
    buffer_load_dwordx4 v[72:75], v1, s[52:55], s42 offen offset:256 nt
    s_add_u32 s42, s42, 49152
    s_cmp_ge_u32 s42, s64
    s_cselect_b32 s42, s43, s42
    s_waitcnt vmcnt(39)
    v_dot2_f32_bf16 v9, v88, v12, 0
    v_dot2_f32_bf16 v10, v100, v12, 0
    v_dot2_f32_bf16 v9, v89, v13, v9
    v_dot2_f32_bf16 v10, v101, v13, v10
    v_dot2_f32_bf16 v9, v90, v14, v9
    v_dot2_f32_bf16 v10, v102, v14, v10
    v_dot2_f32_bf16 v9, v91, v15, v9
    v_dot2_f32_bf16 v10, v103, v15, v10
    v_dot2_f32_bf16 v9, v92, v16, v9
    v_dot2_f32_bf16 v10, v104, v16, v10
    v_dot2_f32_bf16 v9, v93, v17, v9
    v_dot2_f32_bf16 v10, v105, v17, v10
    v_dot2_f32_bf16 v9, v94, v18, v9
    v_dot2_f32_bf16 v10, v106, v18, v10
    v_dot2_f32_bf16 v9, v95, v19, v9
    v_dot2_f32_bf16 v10, v107, v19, v10
    v_dot2_f32_bf16 v9, v96, v20, v9
    v_dot2_f32_bf16 v10, v108, v20, v10
    v_dot2_f32_bf16 v9, v97, v21, v9
    v_dot2_f32_bf16 v10, v109, v21, v10
    v_dot2_f32_bf16 v9, v98, v22, v9
    v_dot2_f32_bf16 v10, v110, v22, v10
    v_dot2_f32_bf16 v9, v99, v23, v9
    v_dot2_f32_bf16 v10, v111, v23, v10
    s_nop 2
    v_add_f32_dpp v9, v9, v9 quad_perm:[1,0,3,2] row_mask:0xf bank_mask:0xf
    v_add_f32_dpp v10, v10, v10 quad_perm:[1,0,3,2] row_mask:0xf bank_mask:0xf
    s_nop 0
    v_add_f32_dpp v9, v9, v9 quad_perm:[2,3,0,1] row_mask:0xf bank_mask:0xf
    v_add_f32_dpp v10, v10, v10 quad_perm:[2,3,0,1] row_mask:0xf bank_mask:0xf
    s_nop 0
    v_add_f32_dpp v9, v9, v9 row_half_mirror row_mask:0xf bank_mask:0xf
    v_add_f32_dpp v10, v10, v10 row_half_mirror row_mask:0xf bank_mask:0xf
    v_cvt_pk_bf16_f32 v6, v9, v10
    v_lshlrev_b32 v9, 16, v6
    v_and_b32 v10, 0xffff0000, v6
    v_mul_f32 v9, s10, v9
    v_mul_f32 v10, s10, v10
    v_cvt_pk_bf16_f32 v6, v9, v10
    ds_write_b32 v2, v6 offset:4
    s_waitcnt vmcnt(33)
    v_dot2_f32_bf16 v9, v112, v12, 0
    v_dot2_f32_bf16 v10, v124, v12, 0
    v_dot2_f32_bf16 v9, v113, v13, v9
    v_dot2_f32_bf16 v10, v125, v13, v10
    v_dot2_f32_bf16 v9, v114, v14, v9
    v_dot2_f32_bf16 v10, v126, v14, v10
    v_dot2_f32_bf16 v9, v115, v15, v9
    v_dot2_f32_bf16 v10, v127, v15, v10
    v_dot2_f32_bf16 v9, v116, v16, v9
    v_dot2_f32_bf16 v10, v128, v16, v10
    v_dot2_f32_bf16 v9, v117, v17, v9
    v_dot2_f32_bf16 v10, v129, v17, v10
    v_dot2_f32_bf16 v9, v118, v18, v9
    v_dot2_f32_bf16 v10, v130, v18, v10
    v_dot2_f32_bf16 v9, v119, v19, v9
    v_dot2_f32_bf16 v10, v131, v19, v10
    v_dot2_f32_bf16 v9, v120, v20, v9
    v_dot2_f32_bf16 v10, v132, v20, v10
    v_dot2_f32_bf16 v9, v121, v21, v9
    v_dot2_f32_bf16 v10, v133, v21, v10
    v_dot2_f32_bf16 v9, v122, v22, v9
    v_dot2_f32_bf16 v10, v134, v22, v10
    v_dot2_f32_bf16 v9, v123, v23, v9
    v_dot2_f32_bf16 v10, v135, v23, v10
    s_nop 2
    v_add_f32_dpp v9, v9, v9 quad_perm:[1,0,3,2] row_mask:0xf bank_mask:0xf
    v_add_f32_dpp v10, v10, v10 quad_perm:[1,0,3,2] row_mask:0xf bank_mask:0xf
    s_nop 0
    v_add_f32_dpp v9, v9, v9 quad_perm:[2,3,0,1] row_mask:0xf bank_mask:0xf
    v_add_f32_dpp v10, v10, v10 quad_perm:[2,3,0,1] row_mask:0xf bank_mask:0xf
    s_nop 0
    v_add_f32_dpp v9, v9, v9 row_half_mirror row_mask:0xf bank_mask:0xf
    v_add_f32_dpp v10, v10, v10 row_half_mirror row_mask:0xf bank_mask:0xf
    v_cvt_pk_bf16_f32 v6, v9, v10
    v_lshlrev_b32 v9, 16, v6
    v_and_b32 v10, 0xffff0000, v6
    v_mul_f32 v9, s10, v9
    v_mul_f32 v10, s10, v10
    v_cvt_pk_bf16_f32 v6, v9, v10
    ds_write_b32 v2, v6 offset:8
    s_waitcnt vmcnt(6)
    buffer_load_dwordx4 v[76:79], v1, s[52:55], s42 offen offset:0 nt
    buffer_load_dwordx4 v[80:83], v1, s[52:55], s42 offen offset:128 nt
    buffer_load_dwordx4 v[84:87], v1, s[52:55], s42 offen offset:256 nt
    s_add_u32 s42, s42, 49152
    s_cmp_ge_u32 s42, s64
    s_cselect_b32 s42, s43, s42
    s_waitcnt vmcnt(30)
    v_dot2_f32_bf16 v9, v136, v12, 0
    v_dot2_f32_bf16 v10, v148, v12, 0
    v_dot2_f32_bf16 v9, v137, v13, v9
    v_dot2_f32_bf16 v10, v149, v13, v10
    v_dot2_f32_bf16 v9, v138, v14, v9
    v_dot2_f32_bf16 v10, v150, v14, v10
    v_dot2_f32_bf16 v9, v139, v15, v9
    v_dot2_f32_bf16 v10, v151, v15, v10
    v_dot2_f32_bf16 v9, v140, v16, v9
    v_dot2_f32_bf16 v10, v152, v16, v10
    v_dot2_f32_bf16 v9, v141, v17, v9
    v_dot2_f32_bf16 v10, v153, v17, v10
    v_dot2_f32_bf16 v9, v142, v18, v9
    v_dot2_f32_bf16 v10, v154, v18, v10
    v_dot2_f32_bf16 v9, v143, v19, v9
    v_dot2_f32_bf16 v10, v155, v19, v10
    v_dot2_f32_bf16 v9, v144, v20, v9
    v_dot2_f32_bf16 v10, v156, v20, v10
    v_dot2_f32_bf16 v9, v145, v21, v9
    v_dot2_f32_bf16 v10, v157, v21, v10
    v_dot2_f32_bf16 v9, v146, v22, v9
    v_dot2_f32_bf16 v10, v158, v22, v10
    v_dot2_f32_bf16 v9, v147, v23, v9
    v_dot2_f32_bf16 v10, v159, v23, v10
    s_nop 2
    v_add_f32_dpp v9, v9, v9 quad_perm:[1,0,3,2] row_mask:0xf bank_mask:0xf
    v_add_f32_dpp v10, v10, v10 quad_perm:[1,0,3,2] row_mask:0xf bank_mask:0xf
    s_nop 0
    v_add_f32_dpp v9, v9, v9 quad_perm:[2,3,0,1] row_mask:0xf bank_mask:0xf
    v_add_f32_dpp v10, v10, v10 quad_perm:[2,3,0,1] row_mask:0xf bank_mask:0xf
    s_nop 0
    v_add_f32_dpp v9, v9, v9 row_half_mirror row_mask:0xf bank_mask:0xf
    v_add_f32_dpp v10, v10, v10 row_half_mirror row_mask:0xf bank_mask:0xf
    v_cvt_pk_bf16_f32 v6, v9, v10
    v_lshlrev_b32 v9, 16, v6
    v_and_b32 v10, 0xffff0000, v6
    v_mul_f32 v9, s10, v9
    v_mul_f32 v10, s10, v10
    v_cvt_pk_bf16_f32 v6, v9, v10
    ds_write_b32 v2, v6 offset:12
    s_waitcnt vmcnt(24)
    v_dot2_f32_bf16 v9, v160, v12, 0
    v_dot2_f32_bf16 v10, v172, v12, 0
    v_dot2_f32_bf16 v9, v161, v13, v9
    v_dot2_f32_bf16 v10, v173, v13, v10
    v_dot2_f32_bf16 v9, v162, v14, v9
    v_dot2_f32_bf16 v10, v174, v14, v10
    v_dot2_f32_bf16 v9, v163, v15, v9
    v_dot2_f32_bf16 v10, v175, v15, v10
    v_dot2_f32_bf16 v9, v164, v16, v9
    v_dot2_f32_bf16 v10, v176, v16, v10
    v_dot2_f32_bf16 v9, v165, v17, v9
    v_dot2_f32_bf16 v10, v177, v17, v10
    v_dot2_f32_bf16 v9, v166, v18, v9
    v_dot2_f32_bf16 v10, v178, v18, v10
    v_dot2_f32_bf16 v9, v167, v19, v9
    v_dot2_f32_bf16 v10, v179, v19, v10
    v_dot2_f32_bf16 v9, v168, v20, v9
    v_dot2_f32_bf16 v10, v180, v20, v10
    v_dot2_f32_bf16 v9, v169, v21, v9
    v_dot2_f32_bf16 v10, v181, v21, v10
    v_dot2_f32_bf16 v9, v170, v22, v9
    v_dot2_f32_bf16 v10, v182, v22, v10
    v_dot2_f32_bf16 v9, v171, v23, v9
    v_dot2_f32_bf16 v10, v183, v23, v10
    s_nop 2
    v_add_f32_dpp v9, v9, v9 quad_perm:[1,0,3,2] row_mask:0xf bank_mask:0xf
    v_add_f32_dpp v10, v10, v10 quad_perm:[1,0,3,2] row_mask:0xf bank_mask:0xf
    s_nop 0
    v_add_f32_dpp v9, v9, v9 quad_perm:[2,3,0,1] row_mask:0xf bank_mask:0xf
    v_add_f32_dpp v10, v10, v10 quad_perm:[2,3,0,1] row_mask:0xf bank_mask:0xf
    s_nop 0
    v_add_f32_dpp v9, v9, v9 row_half_mirror row_mask:0xf bank_mask:0xf
    v_add_f32_dpp v10, v10, v10 row_half_mirror row_mask:0xf bank_mask:0xf
    v_cvt_pk_bf16_f32 v6, v9, v10
    v_lshlrev_b32 v9, 16, v6
    v_and_b32 v10, 0xffff0000, v6
    v_mul_f32 v9, s10, v9
    v_mul_f32 v10, s10, v10
    v_cvt_pk_bf16_f32 v6, v9, v10
    ds_write_b32 v2, v6 offset:16
    s_waitcnt vmcnt(6)
    buffer_load_dwordx4 v[88:91], v1, s[52:55], s42 offen offset:0 nt
    buffer_load_dwordx4 v[92:95], v1, s[52:55], s42 offen offset:128 nt
    buffer_load_dwordx4 v[96:99], v1, s[52:55], s42 offen offset:256 nt
    s_add_u32 s42, s42, 49152
    s_cmp_ge_u32 s42, s64
    s_cselect_b32 s42, s43, s42
    s_waitcnt vmcnt(21)
    v_dot2_f32_bf16 v9, v184, v12, 0
    v_dot2_f32_bf16 v10, v196, v12, 0
    v_dot2_f32_bf16 v9, v185, v13, v9
    v_dot2_f32_bf16 v10, v197, v13, v10
    v_dot2_f32_bf16 v9, v186, v14, v9
    v_dot2_f32_bf16 v10, v198, v14, v10
    v_dot2_f32_bf16 v9, v187, v15, v9
    v_dot2_f32_bf16 v10, v199, v15, v10
    v_dot2_f32_bf16 v9, v188, v16, v9
    v_dot2_f32_bf16 v10, v200, v16, v10
    v_dot2_f32_bf16 v9, v189, v17, v9
    v_dot2_f32_bf16 v10, v201, v17, v10
    v_dot2_f32_bf16 v9, v190, v18, v9
    v_dot2_f32_bf16 v10, v202, v18, v10
    v_dot2_f32_bf16 v9, v191, v19, v9
    v_dot2_f32_bf16 v10, v203, v19, v10
    v_dot2_f32_bf16 v9, v192, v20, v9
    v_dot2_f32_bf16 v10, v204, v20, v10
    v_dot2_f32_bf16 v9, v193, v21, v9
    v_dot2_f32_bf16 v10, v205, v21, v10
    v_dot2_f32_bf16 v9, v194, v22, v9
    v_dot2_f32_bf16 v10, v206, v22, v10
    v_dot2_f32_bf16 v9, v195, v23, v9
    v_dot2_f32_bf16 v10, v207, v23, v10
    s_nop 2
    v_add_f32_dpp v9, v9, v9 quad_perm:[1,0,3,2] row_mask:0xf bank_mask:0xf
    v_add_f32_dpp v10, v10, v10 quad_perm:[1,0,3,2] row_mask:0xf bank_mask:0xf
    s_nop 0
    v_add_f32_dpp v9, v9, v9 quad_perm:[2,3,0,1] row_mask:0xf bank_mask:0xf
    v_add_f32_dpp v10, v10, v10 quad_perm:[2,3,0,1] row_mask:0xf bank_mask:0xf
    s_nop 0
    v_add_f32_dpp v9, v9, v9 row_half_mirror row_mask:0xf bank_mask:0xf
    v_add_f32_dpp v10, v10, v10 row_half_mirror row_mask:0xf bank_mask:0xf
    v_cvt_pk_bf16_f32 v6, v9, v10
    v_lshlrev_b32 v9, 16, v6
    v_and_b32 v10, 0xffff0000, v6
    v_mul_f32 v9, s10, v9
    v_mul_f32 v10, s10, v10
    v_cvt_pk_bf16_f32 v6, v9, v10
    ds_write_b32 v2, v6 offset:20
    s_waitcnt vmcnt(15)
    v_dot2_f32_bf16 v9, v208, v12, 0
    v_dot2_f32_bf16 v10, v220, v12, 0
    v_dot2_f32_bf16 v9, v209, v13, v9
    v_dot2_f32_bf16 v10, v221, v13, v10
    v_dot2_f32_bf16 v9, v210, v14, v9
    v_dot2_f32_bf16 v10, v222, v14, v10
    v_dot2_f32_bf16 v9, v211, v15, v9
    v_dot2_f32_bf16 v10, v223, v15, v10
    v_dot2_f32_bf16 v9, v212, v16, v9
    v_dot2_f32_bf16 v10, v224, v16, v10
    v_dot2_f32_bf16 v9, v213, v17, v9
    v_dot2_f32_bf16 v10, v225, v17, v10
    v_dot2_f32_bf16 v9, v214, v18, v9
    v_dot2_f32_bf16 v10, v226, v18, v10
    v_dot2_f32_bf16 v9, v215, v19, v9
    v_dot2_f32_bf16 v10, v227, v19, v10
    v_dot2_f32_bf16 v9, v216, v20, v9
    v_dot2_f32_bf16 v10, v228, v20, v10
    v_dot2_f32_bf16 v9, v217, v21, v9
    v_dot2_f32_bf16 v10, v229, v21, v10
    v_dot2_f32_bf16 v9, v218, v22, v9
    v_dot2_f32_bf16 v10, v230, v22, v10
    v_dot2_f32_bf16 v9, v219, v23, v9
    v_dot2_f32_bf16 v10, v231, v23, v10
    s_nop 2
    v_add_f32_dpp v9, v9, v9 quad_perm:[1,0,3,2] row_mask:0xf bank_mask:0xf
    v_add_f32_dpp v10, v10, v10 quad_perm:[1,0,3,2] row_mask:0xf bank_mask:0xf
    s_nop 0
    v_add_f32_dpp v9, v9, v9 quad_perm:[2,3,0,1] row_mask:0xf bank_mask:0xf
    v_add_f32_dpp v10, v10, v10 quad_perm:[2,3,0,1] row_mask:0xf bank_mask:0xf
    s_nop 0
    v_add_f32_dpp v9, v9, v9 row_half_mirror row_mask:0xf bank_mask:0xf
    v_add_f32_dpp v10, v10, v10 row_half_mirror row_mask:0xf bank_mask:0xf
    v_cvt_pk_bf16_f32 v6, v9, v10
    v_lshlrev_b32 v9, 16, v6
    v_and_b32 v10, 0xffff0000, v6
    v_mul_f32 v9, s10, v9
    v_mul_f32 v10, s10, v10
    v_cvt_pk_bf16_f32 v6, v9, v10
    ds_write_b32 v2, v6 offset:24
    s_waitcnt vmcnt(9)
    v_dot2_f32_bf16 v9, v232, v12, 0
    v_dot2_f32_bf16 v10, v244, v12, 0
    v_dot2_f32_bf16 v9, v233, v13, v9
    v_dot2_f32_bf16 v10, v245, v13, v10
    v_dot2_f32_bf16 v9, v234, v14, v9
    v_dot2_f32_bf16 v10, v246, v14, v10
    v_dot2_f32_bf16 v9, v235, v15, v9
    v_dot2_f32_bf16 v10, v247, v15, v10
    v_dot2_f32_bf16 v9, v236, v16, v9
    v_dot2_f32_bf16 v10, v248, v16, v10
    v_dot2_f32_bf16 v9, v237, v17, v9
    v_dot2_f32_bf16 v10, v249, v17, v10
    v_dot2_f32_bf16 v9, v238, v18, v9
    v_dot2_f32_bf16 v10, v250, v18, v10
    v_dot2_f32_bf16 v9, v239, v19, v9
    v_dot2_f32_bf16 v10, v251, v19, v10
    v_dot2_f32_bf16 v9, v240, v20, v9
    v_dot2_f32_bf16 v10, v252, v20, v10
    v_dot2_f32_bf16 v9, v241, v21, v9
    v_dot2_f32_bf16 v10, v253, v21, v10
    v_dot2_f32_bf16 v9, v242, v22, v9
    v_dot2_f32_bf16 v10, v254, v22, v10
    v_dot2_f32_bf16 v9, v243, v23, v9
    v_dot2_f32_bf16 v10, v255, v23, v10
    s_nop 2
    v_add_f32_dpp v9, v9, v9 quad_perm:[1,0,3,2] row_mask:0xf bank_mask:0xf
    v_add_f32_dpp v10, v10, v10 quad_perm:[1,0,3,2] row_mask:0xf bank_mask:0xf
    s_nop 0
    v_add_f32_dpp v9, v9, v9 quad_perm:[2,3,0,1] row_mask:0xf bank_mask:0xf
    v_add_f32_dpp v10, v10, v10 quad_perm:[2,3,0,1] row_mask:0xf bank_mask:0xf
    s_nop 0
    v_add_f32_dpp v9, v9, v9 row_half_mirror row_mask:0xf bank_mask:0xf
    v_add_f32_dpp v10, v10, v10 row_half_mirror row_mask:0xf bank_mask:0xf
    v_cvt_pk_bf16_f32 v6, v9, v10
    v_lshlrev_b32 v9, 16, v6
    v_and_b32 v10, 0xffff0000, v6
    v_mul_f32 v9, s10, v9
    v_mul_f32 v10, s10, v10
    v_cvt_pk_bf16_f32 v6, v9, v10
    ds_write_b32 v2, v6 offset:28
    v_add_u32 v2, 32, v2
L_kloop:
    s_waitcnt vmcnt(6)
    buffer_load_dwordx4 v[100:103], v1, s[52:55], s42 offen offset:0 nt
    buffer_load_dwordx4 v[104:107], v1, s[52:55], s42 offen offset:128 nt
    buffer_load_dwordx4 v[108:111], v1, s[52:55], s42 offen offset:256 nt
    s_add_u32 s42, s42, 49152
    s_cmp_ge_u32 s42, s64
    s_cselect_b32 s42, s43, s42
    s_waitcnt vmcnt(6)
    buffer_load_dwordx4 v[112:115], v1, s[52:55], s42 offen offset:0 nt
    buffer_load_dwordx4 v[116:119], v1, s[52:55], s42 offen offset:128 nt
    buffer_load_dwordx4 v[120:123], v1, s[52:55], s42 offen offset:256 nt
    s_add_u32 s42, s42, 49152
    s_cmp_ge_u32 s42, s64
    s_cselect_b32 s42, s43, s42
    v_dot2_f32_bf16 v9, v64, v12, 0
    v_dot2_f32_bf16 v10, v76, v12, 0
    v_dot2_f32_bf16 v9, v65, v13, v9
    v_dot2_f32_bf16 v10, v77, v13, v10
    v_dot2_f32_bf16 v9, v66, v14, v9
    v_dot2_f32_bf16 v10, v78, v14, v10
    v_dot2_f32_bf16 v9, v67, v15, v9
    v_dot2_f32_bf16 v10, v79, v15, v10
    v_dot2_f32_bf16 v9, v68, v16, v9
    v_dot2_f32_bf16 v10, v80, v16, v10
    v_dot2_f32_bf16 v9, v69, v17, v9
    v_dot2_f32_bf16 v10, v81, v17, v10
    v_dot2_f32_bf16 v9, v70, v18, v9
    v_dot2_f32_bf16 v10, v82, v18, v10
    v_dot2_f32_bf16 v9, v71, v19, v9
    v_dot2_f32_bf16 v10, v83, v19, v10
    v_dot2_f32_bf16 v9, v72, v20, v9
    v_dot2_f32_bf16 v10, v84, v20, v10
    v_dot2_f32_bf16 v9, v73, v21, v9
    v_dot2_f32_bf16 v10, v85, v21, v10
    v_dot2_f32_bf16 v9, v74, v22, v9
    v_dot2_f32_bf16 v10, v86, v22, v10
    v_dot2_f32_bf16 v9, v75, v23, v9
    v_dot2_f32_bf16 v10, v87, v23, v10
    s_nop 2
    v_add_f32_dpp v9, v9, v9 quad_perm:[1,0,3,2] row_mask:0xf bank_mask:0xf
    v_add_f32_dpp v10, v10, v10 quad_perm:[1,0,3,2] row_mask:0xf bank_mask:0xf
    s_nop 0
    v_add_f32_dpp v9, v9, v9 quad_perm:[2,3,0,1] row_mask:0xf bank_mask:0xf
    v_add_f32_dpp v10, v10, v10 quad_perm:[2,3,0,1] row_mask:0xf bank_mask:0xf
    s_nop 0
    v_add_f32_dpp v9, v9, v9 row_half_mirror row_mask:0xf bank_mask:0xf
    v_add_f32_dpp v10, v10, v10 row_half_mirror row_mask:0xf bank_mask:0xf
    v_cvt_pk_bf16_f32 v6, v9, v10
    v_lshlrev_b32 v9, 16, v6
    v_and_b32 v10, 0xffff0000, v6
    v_mul_f32 v9, s10, v9
    v_mul_f32 v10, s10, v10
    v_cvt_pk_bf16_f32 v6, v9, v10
    ds_write_b32 v2, v6 offset:0
    s_waitcnt vmcnt(6)
    buffer_load_dwordx4 v[124:127], v1, s[52:55], s42 offen offset:0 nt
    buffer_load_dwordx4 v[128:131], v1, s[52:55], s42 offen offset:128 nt
    buffer_load_dwordx4 v[132:135], v1, s[52:55], s42 offen offset:256 nt
    s_add_u32 s42, s42, 49152
    s_cmp_ge_u32 s42, s64
    s_cselect_b32 s42, s43, s42
    s_cmp_eq_u32 s66, 7
    s_cselect_b32 s52, s20, s52
    s_cselect_b32 s53, s21, s53
    s_waitcnt vmcnt(6)
    buffer_load_dwordx4 v[64:67], v1, s[52:55], s42 offen offset:0 nt
    buffer_load_dwordx4 v[68:71], v1, s[52:55], s42 offen offset:128 nt
    buffer_load_dwordx4 v[72:75], v1, s[52:55], s42 offen offset:256 nt
    s_add_u32 s42, s42, 49152
    s_cmp_ge_u32 s42, s64
    s_cselect_b32 s42, s43, s42
    v_dot2_f32_bf16 v9, v88, v12, 0
    v_dot2_f32_bf16 v10, v100, v12, 0
    v_dot2_f32_bf16 v9, v89, v13, v9
    v_dot2_f32_bf16 v10, v101, v13, v10
    v_dot2_f32_bf16 v9, v90, v14, v9
    v_dot2_f32_bf16 v10, v102, v14, v10
    v_dot2_f32_bf16 v9, v91, v15, v9
    v_dot2_f32_bf16 v10, v103, v15, v10
    v_dot2_f32_bf16 v9, v92, v16, v9
    v_dot2_f32_bf16 v10, v104, v16, v10
    v_dot2_f32_bf16 v9, v93, v17, v9
    v_dot2_f32_bf16 v10, v105, v17, v10
    v_dot2_f32_bf16 v9, v94, v18, v9
    v_dot2_f32_bf16 v10, v106, v18, v10
    v_dot2_f32_bf16 v9, v95, v19, v9
    v_dot2_f32_bf16 v10, v107, v19, v10
    v_dot2_f32_bf16 v9, v96, v20, v9
    v_dot2_f32_bf16 v10, v108, v20, v10
    v_dot2_f32_bf16 v9, v97, v21, v9
    v_dot2_f32_bf16 v10, v109, v21, v10
    v_dot2_f32_bf16 v9, v98, v22, v9
    v_dot2_f32_bf16 v10, v110, v22, v10
    v_dot2_f32_bf16 v9, v99, v23, v9
    v_dot2_f32_bf16 v10, v111, v23, v10
    s_nop 2
    v_add_f32_dpp v9, v9, v9 quad_perm:[1,0,3,2] row_mask:0xf bank_mask:0xf
    v_add_f32_dpp v10, v10, v10 quad_perm:[1,0,3,2] row_mask:0xf bank_mask:0xf
    s_nop 0
    v_add_f32_dpp v9, v9, v9 quad_perm:[2,3,0,1] row_mask:0xf bank_mask:0xf
    v_add_f32_dpp v10, v10, v10 quad_perm:[2,3,0,1] row_mask:0xf bank_mask:0xf
    s_nop 0
    v_add_f32_dpp v9, v9, v9 row_half_mirror row_mask:0xf bank_mask:0xf
    v_add_f32_dpp v10, v10, v10 row_half_mirror row_mask:0xf bank_mask:0xf
    v_cvt_pk_bf16_f32 v6, v9, v10
    v_lshlrev_b32 v9, 16, v6
    v_and_b32 v10, 0xffff0000, v6
    v_mul_f32 v9, s10, v9
    v_mul_f32 v10, s10, v10
    v_cvt_pk_bf16_f32 v6, v9, v10
    ds_write_b32 v2, v6 offset:4
    s_waitcnt vmcnt(6)
    buffer_load_dwordx4 v[76:79], v1, s[52:55], s42 offen offset:0 nt
    buffer_load_dwordx4 v[80:83], v1, s[52:55], s42 offen offset:128 nt
    buffer_load_dwordx4 v[84:87], v1, s[52:55], s42 offen offset:256 nt
    s_add_u32 s42, s42, 49152
    s_cmp_ge_u32 s42, s64
    s_cselect_b32 s42, s43, s42
    s_waitcnt vmcnt(6)
    buffer_load_dwordx4 v[88:91], v1, s[52:55], s42 offen offset:0 nt
    buffer_load_dwordx4 v[92:95], v1, s[52:55], s42 offen offset:128 nt
    buffer_load_dwordx4 v[96:99], v1, s[52:55], s42 offen offset:256 nt
    s_add_u32 s42, s42, 49152
    s_cmp_ge_u32 s42, s64
    s_cselect_b32 s42, s43, s42
    v_dot2_f32_bf16 v9, v112, v12, 0
    v_dot2_f32_bf16 v10, v124, v12, 0
    v_dot2_f32_bf16 v9, v113, v13, v9
    v_dot2_f32_bf16 v10, v125, v13, v10
    v_dot2_f32_bf16 v9, v114, v14, v9
    v_dot2_f32_bf16 v10, v126, v14, v10
    v_dot2_f32_bf16 v9, v115, v15, v9
    v_dot2_f32_bf16 v10, v127, v15, v10
    v_dot2_f32_bf16 v9, v116, v16, v9
    v_dot2_f32_bf16 v10, v128, v16, v10
    v_dot2_f32_bf16 v9, v117, v17, v9
    v_dot2_f32_bf16 v10, v129, v17, v10
    v_dot2_f32_bf16 v9, v118, v18, v9
    v_dot2_f32_bf16 v10, v130, v18, v10
    v_dot2_f32_bf16 v9, v119, v19, v9
    v_dot2_f32_bf16 v10, v131, v19, v10
    v_dot2_f32_bf16 v9, v120, v20, v9
    v_dot2_f32_bf16 v10, v132, v20, v10
    v_dot2_f32_bf16 v9, v121, v21, v9
    v_dot2_f32_bf16 v10, v133, v21, v10
    v_dot2_f32_bf16 v9, v122, v22, v9
    v_dot2_f32_bf16 v10, v134, v22, v10
    v_dot2_f32_bf16 v9, v123, v23, v9
    v_dot2_f32_bf16 v10, v135, v23, v10
    s_nop 2
    v_add_f32_dpp v9, v9, v9 quad_perm:[1,0,3,2] row_mask:0xf bank_mask:0xf
    v_add_f32_dpp v10, v10, v10 quad_perm:[1,0,3,2] row_mask:0xf bank_mask:0xf
    s_nop 0
    v_add_f32_dpp v9, v9, v9 quad_perm:[2,3,0,1] row_mask:0xf bank_mask:0xf
    v_add_f32_dpp v10, v10, v10 quad_perm:[2,3,0,1] row_mask:0xf bank_mask:0xf
    s_nop 0
    v_add_f32_dpp v9, v9, v9 row_half_mirror row_mask:0xf bank_mask:0xf
    v_add_f32_dpp v10, v10, v10 row_half_mirror row_mask:0xf bank_mask:0xf
    v_cvt_pk_bf16_f32 v6, v9, v10
    v_lshlrev_b32 v9, 16, v6
    v_and_b32 v10, 0xffff0000, v6
    v_mul_f32 v9, s10, v9
    v_mul_f32 v10, s10, v10
    v_cvt_pk_bf16_f32 v6, v9, v10
    ds_write_b32 v2, v6 offset:8
    v_add_u32 v2, 12, v2
    s_add_u32 s66, s66, 1
    s_cmp_lt_u32 s66, 8
    s_cbranch_scc1 L_kloop
    buffer_load_dwordx4 v[100:103], v1, s[52:55], s42 offen offset:0 nt
    buffer_load_dwordx4 v[104:107], v1, s[52:55], s42 offen offset:128 nt
    buffer_load_dwordx4 v[108:111], v1, s[52:55], s42 offen offset:256 nt
    s_add_u32 s42, s42, 49152
    s_cmp_ge_u32 s42, s64
    s_cselect_b32 s42, s43, s42
    v_lshl_add_u32 v6, v5, 4, v3
    s_memrealtime s[46:47]
    s_waitcnt lgkmcnt(0)
    ds_read_b128 v[40:43], v6
    s_waitcnt lgkmcnt(0)
    v_lshlrev_b32 v32, 16, v40
    v_and_b32 v33, 0xffff0000, v40
    v_lshlrev_b32 v34, 16, v41
    v_and_b32 v35, 0xffff0000, v41
    v_lshlrev_b32 v36, 16, v42
    v_and_b32 v37, 0xffff0000, v42
    v_lshlrev_b32 v38, 16, v43
    v_and_b32 v39, 0xffff0000, v43
    v_max3_f32 v9, v32, v33, v34
    v_max3_f32 v9, v9, v35, v36
    v_max3_f32 v9, v9, v37, v38
    v_max_f32 v9, v9, v39
    s_nop 1
    v_max_f32_dpp v9, v9, v9 row_ror:1 row_mask:0xf bank_mask:0xf
    s_nop 1
    v_max_f32_dpp v9, v9, v9 row_ror:2 row_mask:0xf bank_mask:0xf
    s_nop 1
    v_max_f32_dpp v9, v9, v9 row_ror:4 row_mask:0xf bank_mask:0xf
    s_nop 1
    v_max_f32_dpp v9, v9, v9 row_ror:8 row_mask:0xf bank_mask:0xf
    v_mov_b32 v7, v9
    s_nop 1
    v_permlane16_swap_b32 v9, v7
    s_nop 1
    v_max_f32 v9, v9, v7
    v_mov_b32 v7, v9
    s_nop 1
    v_permlane32_swap_b32 v9, v7
    s_nop 1
    v_max_f32 v9, v9, v7
    v_sub_f32 v32, v32, v9
    v_mul_f32 v32, 1069066811, v32
    v_sub_f32 v33, v33, v9
    v_mul_f32 v33, 1069066811, v33
    v_sub_f32 v34, v34, v9
    v_mul_f32 v34, 1069066811, v34
    v_sub_f32 v35, v35, v9
    v_mul_f32 v35, 1069066811, v35
    v_sub_f32 v36, v36, v9
    v_mul_f32 v36, 1069066811, v36
    v_sub_f32 v37, v37, v9
    v_mul_f32 v37, 1069066811, v37
    v_sub_f32 v38, v38, v9
    v_mul_f32 v38, 1069066811, v38
    v_sub_f32 v39, v39, v9
    v_mul_f32 v39, 1069066811, v39
    v_exp_f32 v32, v32
    v_exp_f32 v33, v33
    v_exp_f32 v34, v34
    v_exp_f32 v35, v35
    v_exp_f32 v36, v36
    v_exp_f32 v37, v37
    v_exp_f32 v38, v38
    v_exp_f32 v39, v39
    s_nop 0
    v_add_f32 v10, v32, v33
    v_add_f32 v10, v10, v34
    v_add_f32 v10, v10, v35
    v_add_f32 v10, v10, v36
    v_add_f32 v10, v10, v37
    v_add_f32 v10, v10, v38
    v_add_f32 v10, v10, v39
    v_cvt_pk_bf16_f32 v40, v32, v33
    v_cvt_pk_bf16_f32 v41, v34, v35
    v_cvt_pk_bf16_f32 v42, v36, v37
    v_cvt_pk_bf16_f32 v43, v38, v39
    ds_write_b128 v6, v[40:43]
    s_nop 1
    v_add_f32_dpp v10, v10, v10 row_ror:1 row_mask:0xf bank_mask:0xf
    s_nop 1
    v_add_f32_dpp v10, v10, v10 row_ror:2 row_mask:0xf bank_mask:0xf
    s_nop 1
    v_add_f32_dpp v10, v10, v10 row_ror:4 row_mask:0xf bank_mask:0xf
    s_nop 1
    v_add_f32_dpp v10, v10, v10 row_ror:8 row_mask:0xf bank_mask:0xf
    v_mov_b32 v7, v10
    s_nop 1
    v_permlane16_swap_b32 v10, v7
    s_nop 1
    v_add_f32 v10, v10, v7
    v_mov_b32 v7, v10
    s_nop 1
    v_permlane32_swap_b32 v10, v7
    s_nop 1
    v_add_f32 v10, v10, v7
    s_waitcnt lgkmcnt(0)
    ds_read_b64 v[52:53], v3
    v_add_u32 v3, 8, v3
    v_bfi_b32 v44, v11, s96, v9
    v_bfi_b32 v45, v11, s97, v10
    v_mov_b32 v46, s78
    v_mov_b32 v47, s46
    s_lshl_b32 s9, s3, 4
    v_mov_b32 v9, s9
    s_mov_b64 exec, 1
    ds_write_b128 v9, v[44:47] offset:11584
    s_mov_b64 exec, -1
    s_mov_b32 s79, 0xfffff000
    s_mul_i32 s10, s78, 0x9e3779b1
    s_and_b32 s96, s78, 0xfff
    s_bfe_u32 s97, s10, 0xc0008
    s_lshr_b32 s98, s10, 20
    s_mul_i32 s10, s78, 0x85ebca6b
    s_lshr_b32 s99, s10, 20
    v_mov_b32 v11, s96
    s_mov_b32 exec_lo, 0x22222222
    v_mov_b32 v11, s97
    s_mov_b32 exec_lo, 0x44444444
    v_mov_b32 v11, s98
    s_mov_b32 exec_lo, 0x88888888
    v_mov_b32 v11, s99
    s_mov_b32 exec_lo, -1
    v_mov_b32 v32, 0
    v_mov_b32 v33, 0
    v_mov_b32 v34, 0
    v_mov_b32 v35, 0
    v_mov_b32 v36, 0
    v_mov_b32 v37, 0
    v_mov_b32 v38, 0
    v_mov_b32 v39, 0
    v_mov_b32 v40, 0
    v_mov_b32 v41, 0
    v_mov_b32 v42, 0
    v_mov_b32 v43, 0
    s_mov_b32 s66, 0
    s_waitcnt lgkmcnt(0)
    v_and_b32 v4, 7, v0
    v_mul_u32_u24 v4, 416, v4
    v_lshrrev_b32 v5, 4, v0
    v_lshl_add_u32 v4, v5, 4, v4
    v_bfe_u32 v6, v0, 3, 1
    v_mul_u32_u24 v7, 192, v6
    v_add_u32 v4, v4, v7
    v_mul_u32_u24 v18, 0xaaaa, v6
    v_add_u32 v18, 0x4444, v18
    v_lshl_or_b32 v18, v18, 16, v18
    v_and_b32 v6, 1, v5
    v_and_b32 v7, 31, v0
    v_lshlrev_b32 v7, 2, v7
    v_lshlrev_b32 v6, 3, v6
    v_lshlrev_b32 v5, 8, v5
    v_bfe_u32 v9, v0, 3, 1
    v_lshl_add_u32 v5, v9, 4, v5
    v_and_b32 v9, 7, v0
    v_mul_u32_u24 v9, 1040, v9
    s_lshl_b32 s9, s3, 6
    s_add_u32 s9, s9, 12288
    v_add3_u32 v5, v5, v9, s9
    s_mul_i32 s9, s7, 2560
    s_lshl_b32 s11, s3, 7
    s_add_u32 s9, s9, s11
    s_add_u32 s9, s9, 2048
    s_mov_b32 s67, s9
    v_mov_b32 v62, 0
    s_mov_b32 s44, 0
    s_mov_b32 s45, 0
    s_cmp_lg_u32 s3, 0
    s_cbranch_scc1 pg_1
    v_mov_b32 v63, 1
    v_lshlrev_b32 v60, 2, v63
    v_mov_b32 v61, s46
    ds_write_b32 v60, v61 offset:62208
    ds_write_b32 v62, v63 offset:11056
pg_1:
    v_perm_b32 v48, v52, v52, v24
    v_perm_b32 v49, v52, v52, v25
    v_perm_b32 v50, v52, v52, v26
    v_perm_b32 v51, v52, v52, v27
    s_waitcnt vmcnt(9)
    s_nop 0
    v_mfma_f32_16x16x32_bf16 v[32:35], v[48:51], v[64:67], v[32:35]
    v_mfma_f32_16x16x32_bf16 v[36:39], v[48:51], v[68:71], v[36:39]
    v_mfma_f32_16x16x32_bf16 v[40:43], v[48:51], v[72:75], v[40:43]
    v_perm_b32 v44, v52, v52, v28
    v_perm_b32 v45, v52, v52, v29
    v_perm_b32 v46, v52, v52, v30
    v_perm_b32 v47, v52, v52, v31
    s_waitcnt vmcnt(3)
    buffer_load_dwordx4 v[112:115], v1, s[52:55], s42 offen offset:0 nt
    buffer_load_dwordx4 v[116:119], v1, s[52:55], s42 offen offset:128 nt
    buffer_load_dwordx4 v[120:123], v1, s[52:55], s42 offen offset:256 nt
    s_add_u32 s42, s42, 49152
    s_cmp_ge_u32 s42, s64
    s_cselect_b32 s42, s43, s42
    v_mfma_f32_16x16x32_bf16 v[32:35], v[44:47], v[76:79], v[32:35]
    v_mfma_f32_16x16x32_bf16 v[36:39], v[44:47], v[80:83], v[36:39]
    v_mfma_f32_16x16x32_bf16 v[40:43], v[44:47], v[84:87], v[40:43]
    v_perm_b32 v48, v53, v53, v24
    v_perm_b32 v49, v53, v53, v25
    v_perm_b32 v50, v53, v53, v26
    v_perm_b32 v51, v53, v53, v27
    s_waitcnt vmcnt(3)
    buffer_load_dwordx4 v[124:127], v1, s[52:55], s42 offen offset:0 nt
    buffer_load_dwordx4 v[128:131], v1, s[52:55], s42 offen offset:128 nt
    buffer_load_dwordx4 v[132:135], v1, s[52:55], s42 offen offset:256 nt
    s_add_u32 s42, s42, 49152
    s_cmp_ge_u32 s42, s64
    s_cselect_b32 s42, s43, s42
    v_mfma_f32_16x16x32_bf16 v[32:35], v[48:51], v[88:91], v[32:35]
    v_mfma_f32_16x16x32_bf16 v[36:39], v[48:51], v[92:95], v[36:39]
    v_mfma_f32_16x16x32_bf16 v[40:43], v[48:51], v[96:99], v[40:43]
    v_perm_b32 v44, v53, v53, v28
    v_perm_b32 v45, v53, v53, v29
    v_perm_b32 v46, v53, v53, v30
    v_perm_b32 v47, v53, v53, v31
    ds_read_b32 v52, v3
    ds_read_b32 v53, v3 offset:4
    ds_read_b32 v54, v3 offset:8
    v_add_u32 v3, 12, v3
    ds_read_b32 v63, v62 offset:11060
    s_waitcnt vmcnt(3)
    buffer_load_dwordx4 v[64:67], v1, s[52:55], s42 offen offset:0 nt
    buffer_load_dwordx4 v[68:71], v1, s[52:55], s42 offen offset:128 nt
    buffer_load_dwordx4 v[72:75], v1, s[52:55], s42 offen offset:256 nt
    s_add_u32 s42, s42, 49152
    s_cmp_ge_u32 s42, s64
    s_cselect_b32 s42, s43, s42
    v_mfma_f32_16x16x32_bf16 v[32:35], v[44:47], v[100:103], v[32:35]
    v_mfma_f32_16x16x32_bf16 v[36:39], v[44:47], v[104:107], v[36:39]
    v_mfma_f32_16x16x32_bf16 v[40:43], v[44:47], v[108:111], v[40:43]
L_vloop:
    s_memrealtime s[46:47]
    s_waitcnt lgkmcnt(0)
    v_readfirstlane_b32 s9, v63
    s_sext_i32_i16 s11, s9
    s_cmp_lg_u32 s9, s45
    s_cselect_b32 s44, s11, s44
    s_mov_b32 s45, s9
    s_add_u32 s9, s66, 2
    s_cmp_lg_u32 s3, 0
    s_cbranch_scc1 pg_2
    v_mov_b32 v63, s9
    v_lshlrev_b32 v60, 2, v63
    v_mov_b32 v61, s46
    ds_write_b32 v60, v61 offset:62208
    ds_write_b32 v62, v63 offset:11056
pg_2:
    v_perm_b32 v48, v52, v52, v24
    v_perm_b32 v49, v52, v52, v25
    v_perm_b32 v50, v52, v52, v26
    v_perm_b32 v51, v52, v52, v27
    s_waitcnt vmcnt(6)
    s_cmp_gt_i32 s44, 0
    s_cbranch_scc1 bo_3
    s_waitcnt vmcnt(3)
    s_cmp_eq_u32 s44, 0
    s_cbranch_scc1 bc_4
    s_waitcnt vmcnt(1)
    s_add_i32 s44, s44, 2
bo_3:
    s_sub_i32 s44, s44, 1
bc_4:
    buffer_load_dwordx4 v[76:79], v1, s[52:55], s42 offen offset:0 nt
    buffer_load_dwordx4 v[80:83], v1, s[52:55], s42 offen offset:128 nt
    buffer_load_dwordx4 v[84:87], v1, s[52:55], s42 offen offset:256 nt
    s_add_u32 s42, s42, 49152
    s_cmp_ge_u32 s42, s64
    s_cselect_b32 s42, s43, s42
    v_mfma_f32_16x16x32_bf16 v[32:35], v[48:51], v[112:115], v[32:35]
    v_mfma_f32_16x16x32_bf16 v[36:39], v[48:51], v[116:119], v[36:39]
    v_mfma_f32_16x16x32_bf16 v[40:43], v[48:51], v[120:123], v[40:43]
    v_perm_b32 v44, v52, v52, v28
    v_perm_b32 v45, v52, v52, v29
    v_perm_b32 v46, v52, v52, v30
    v_perm_b32 v47, v52, v52, v31
    s_waitcnt vmcnt(6)
    s_cmp_gt_i32 s44, 0
    s_cbranch_scc1 bo_5
    s_waitcnt vmcnt(3)
    s_cmp_eq_u32 s44, 0
    s_cbranch_scc1 bc_6
    s_waitcnt vmcnt(1)
    s_add_i32 s44, s44, 2
bo_5:
    s_sub_i32 s44, s44, 1
bc_6:
    buffer_load_dwordx4 v[88:91], v1, s[52:55], s42 offen offset:0 nt
    buffer_load_dwordx4 v[92:95], v1, s[52:55], s42 offen offset:128 nt
    buffer_load_dwordx4 v[96:99], v1, s[52:55], s42 offen offset:256 nt
    s_add_u32 s42, s42, 49152
    s_cmp_ge_u32 s42, s64
    s_cselect_b32 s42, s43, s42
    v_mfma_f32_16x16x32_bf16 v[32:35], v[44:47], v[124:127], v[32:35]
    v_mfma_f32_16x16x32_bf16 v[36:39], v[44:47], v[128:131], v[36:39]
    v_mfma_f32_16x16x32_bf16 v[40:43], v[44:47], v[132:135], v[40:43]
    v_perm_b32 v48, v53, v53, v24
    v_perm_b32 v49, v53, v53, v25
    v_perm_b32 v50, v53, v53, v26
    v_perm_b32 v51, v53, v53, v27
    s_waitcnt vmcnt(6)
    s_cmp_gt_i32 s44, 0
    s_cbranch_scc1 bo_7
    s_waitcnt vmcnt(3)
    s_cmp_eq_u32 s44, 0
    s_cbranch_scc1 bc_8
    s_waitcnt vmcnt(1)
    s_add_i32 s44, s44, 2
bo_7:
    s_sub_i32 s44, s44, 1
bc_8:
    buffer_load_dwordx4 v[100:103], v1, s[52:55], s42 offen offset:0 nt
    buffer_load_dwordx4 v[104:107], v1, s[52:55], s42 offen offset:128 nt
    buffer_load_dwordx4 v[108:111], v1, s[52:55], s42 offen offset:256 nt
    s_add_u32 s42, s42, 49152
    s_cmp_ge_u32 s42, s64
    s_cselect_b32 s42, s43, s42
    v_mfma_f32_16x16x32_bf16 v[32:35], v[48:51], v[64:67], v[32:35]
    v_mfma_f32_16x16x32_bf16 v[36:39], v[48:51], v[68:71], v[36:39]
    v_mfma_f32_16x16x32_bf16 v[40:43], v[48:51], v[72:75], v[40:43]
    v_perm_b32 v44, v53, v53, v28
    v_perm_b32 v45, v53, v53, v29
    v_perm_b32 v46, v53, v53, v30
    v_perm_b32 v47, v53, v53, v31
    s_waitcnt vmcnt(6)
    s_cmp_gt_i32 s44, 0
    s_cbranch_scc1 bo_9
    s_waitcnt vmcnt(3)
    s_cmp_eq_u32 s44, 0
    s_cbranch_scc1 bc_10
    s_waitcnt vmcnt(1)
    s_add_i32 s44, s44, 2
bo_9:
    s_sub_i32 s44, s44, 1
bc_10:
    buffer_load_dwordx4 v[112:115], v1, s[52:55], s42 offen offset:0 nt
    buffer_load_dwordx4 v[116:119], v1, s[52:55], s42 offen offset:128 nt
    buffer_load_dwordx4 v[120:123], v1, s[52:55], s42 offen offset:256 nt
    s_add_u32 s42, s42, 49152
    s_cmp_ge_u32 s42, s64
    s_cselect_b32 s42, s43, s42
    v_mfma_f32_16x16x32_bf16 v[32:35], v[44:47], v[76:79], v[32:35]
    v_mfma_f32_16x16x32_bf16 v[36:39], v[44:47], v[80:83], v[36:39]
    v_mfma_f32_16x16x32_bf16 v[40:43], v[44:47], v[84:87], v[40:43]
    v_perm_b32 v48, v54, v54, v24
    v_perm_b32 v49, v54, v54, v25
    v_perm_b32 v50, v54, v54, v26
    v_perm_b32 v51, v54, v54, v27
    s_waitcnt vmcnt(6)
    s_cmp_gt_i32 s44, 0
    s_cbranch_scc1 bo_11
    s_waitcnt vmcnt(3)
    s_cmp_eq_u32 s44, 0
    s_cbranch_scc1 bc_12
    s_waitcnt vmcnt(1)
    s_add_i32 s44, s44, 2
bo_11:
    s_sub_i32 s44, s44, 1
bc_12:
    buffer_load_dwordx4 v[124:127], v1, s[52:55], s42 offen offset:0 nt
    buffer_load_dwordx4 v[128:131], v1, s[52:55], s42 offen offset:128 nt
    buffer_load_dwordx4 v[132:135], v1, s[52:55], s42 offen offset:256 nt
    s_add_u32 s42, s42, 49152
    s_cmp_ge_u32 s42, s64
    s_cselect_b32 s42, s43, s42
    v_mfma_f32_16x16x32_bf16 v[32:35], v[48:51], v[88:91], v[32:35]
    v_mfma_f32_16x16x32_bf16 v[36:39], v[48:51], v[92:95], v[36:39]
    v_mfma_f32_16x16x32_bf16 v[40:43], v[48:51], v[96:99], v[40:43]
    v_perm_b32 v44, v54, v54, v28
    v_perm_b32 v45, v54, v54, v29
    v_perm_b32 v46, v54, v54, v30
    v_perm_b32 v47, v54, v54, v31
    ds_read_b32 v52, v3
    ds_read_b32 v53, v3 offset:4
    ds_read_b32 v54, v3 offset:8
    v_add_u32 v3, 12, v3
    ds_read_b32 v63, v62 offset:11060
    s_waitcnt vmcnt(6)
    s_cmp_gt_i32 s44, 0
    s_cbranch_scc1 bo_13
    s_waitcnt vmcnt(3)
    s_cmp_eq_u32 s44, 0
    s_cbranch_scc1 bc_14
    s_waitcnt vmcnt(1)
    s_add_i32 s44, s44, 2
bo_13:
    s_sub_i32 s44, s44, 1
bc_14:
    buffer_load_dwordx4 v[64:67], v1, s[52:55], s42 offen offset:0 nt
    buffer_load_dwordx4 v[68:71], v1, s[52:55], s42 offen offset:128 nt
    buffer_load_dwordx4 v[72:75], v1, s[52:55], s42 offen offset:256 nt
    s_add_u32 s42, s42, 49152
    s_cmp_ge_u32 s42, s64
    s_cselect_b32 s42, s43, s42
    v_mfma_f32_16x16x32_bf16 v[32:35], v[44:47], v[100:103], v[32:35]
    v_mfma_f32_16x16x32_bf16 v[36:39], v[44:47], v[104:107], v[36:39]
    v_mfma_f32_16x16x32_bf16 v[40:43], v[44:47], v[108:111], v[40:43]
    s_add_u32 s66, s66, 1
    s_cmp_lt_u32 s66, 8
    s_cbranch_scc1 L_vloop
    s_waitcnt lgkmcnt(0)
    v_readfirstlane_b32 s9, v63
    s_sext_i32_i16 s11, s9
    s_cmp_lg_u32 s9, s45
    s_cselect_b32 s44, s11, s44
    v_perm_b32 v48, v52, v52, v24
    v_perm_b32 v49, v52, v52, v25
    v_perm_b32 v50, v52, v52, v26
    v_perm_b32 v51, v52, v52, v27
    s_waitcnt vmcnt(6)
    s_cmp_gt_i32 s44, 0
    s_cbranch_scc1 bo_15
    s_waitcnt vmcnt(3)
    s_cmp_eq_u32 s44, 0
    s_cbranch_scc1 bc_16
    s_waitcnt vmcnt(1)
    s_add_i32 s44, s44, 2
bo_15:
    s_sub_i32 s44, s44, 1
bc_16:
    buffer_load_dwordx4 v[136:139], v1, s[52:55], s42 offen offset:0 nt
    buffer_load_dwordx4 v[140:143], v1, s[52:55], s42 offen offset:128 nt
    buffer_load_dwordx4 v[144:147], v1, s[52:55], s42 offen offset:256 nt
    s_add_u32 s42, s42, 49152
    s_cmp_ge_u32 s42, s64
    s_cselect_b32 s42, s43, s42
    v_mfma_f32_16x16x32_bf16 v[32:35], v[48:51], v[112:115], v[32:35]
    v_mfma_f32_16x16x32_bf16 v[36:39], v[48:51], v[116:119], v[36:39]
    v_mfma_f32_16x16x32_bf16 v[40:43], v[48:51], v[120:123], v[40:43]
    v_perm_b32 v44, v52, v52, v28
    v_perm_b32 v45, v52, v52, v29
    v_perm_b32 v46, v52, v52, v30
    v_perm_b32 v47, v52, v52, v31
    s_waitcnt vmcnt(6)
    s_cmp_gt_i32 s44, 0
    s_cbranch_scc1 bo_17
    s_waitcnt vmcnt(3)
    s_cmp_eq_u32 s44, 0
    s_cbranch_scc1 bc_18
    s_waitcnt vmcnt(1)
    s_add_i32 s44, s44, 2
bo_17:
    s_sub_i32 s44, s44, 1
bc_18:
    buffer_load_dwordx4 v[148:151], v1, s[52:55], s42 offen offset:0 nt
    buffer_load_dwordx4 v[152:155], v1, s[52:55], s42 offen offset:128 nt
    buffer_load_dwordx4 v[156:159], v1, s[52:55], s42 offen offset:256 nt
    s_add_u32 s42, s42, 49152
    s_cmp_ge_u32 s42, s64
    s_cselect_b32 s42, s43, s42
    v_mfma_f32_16x16x32_bf16 v[32:35], v[44:47], v[124:127], v[32:35]
    v_mfma_f32_16x16x32_bf16 v[36:39], v[44:47], v[128:131], v[36:39]
    v_mfma_f32_16x16x32_bf16 v[40:43], v[44:47], v[132:135], v[40:43]
    v_perm_b32 v48, v53, v53, v24
    v_perm_b32 v49, v53, v53, v25
    v_perm_b32 v50, v53, v53, v26
    v_perm_b32 v51, v53, v53, v27
    s_waitcnt vmcnt(6)
    s_cmp_gt_i32 s44, 0
    s_cbranch_scc1 bo_19
    s_waitcnt vmcnt(3)
    s_cmp_eq_u32 s44, 0
    s_cbranch_scc1 bc_20
    s_waitcnt vmcnt(1)
    s_add_i32 s44, s44, 2
bo_19:
    s_sub_i32 s44, s44, 1
bc_20:
    buffer_load_dwordx4 v[160:163], v1, s[52:55], s42 offen offset:0 nt
    buffer_load_dwordx4 v[164:167], v1, s[52:55], s42 offen offset:128 nt
    buffer_load_dwordx4 v[168:171], v1, s[52:55], s42 offen offset:256 nt
    s_add_u32 s42, s42, 49152
    s_cmp_ge_u32 s42, s64
    s_cselect_b32 s42, s43, s42
    v_mfma_f32_16x16x32_bf16 v[32:35], v[48:51], v[64:67], v[32:35]
    v_mfma_f32_16x16x32_bf16 v[36:39], v[48:51], v[68:71], v[36:39]
    v_mfma_f32_16x16x32_bf16 v[40:43], v[48:51], v[72:75], v[40:43]
    v_perm_b32 v44, v53, v53, v28
    v_perm_b32 v45, v53, v53, v29
    v_perm_b32 v46, v53, v53, v30
    v_perm_b32 v47, v53, v53, v31
    s_waitcnt vmcnt(6)
    s_cmp_gt_i32 s44, 0
    s_cbranch_scc1 bo_21
    s_waitcnt vmcnt(3)
    s_cmp_eq_u32 s44, 0
    s_cbranch_scc1 bc_22
    s_waitcnt vmcnt(1)
    s_add_i32 s44, s44, 2
bo_21:
    s_sub_i32 s44, s44, 1
bc_22:
    buffer_load_dwordx4 v[172:175], v1, s[52:55], s42 offen offset:0 nt
    buffer_load_dwordx4 v[176:179], v1, s[52:55], s42 offen offset:128 nt
    buffer_load_dwordx4 v[180:183], v1, s[52:55], s42 offen offset:256 nt
    s_add_u32 s42, s42, 49152
    s_cmp_ge_u32 s42, s64
    s_cselect_b32 s42, s43, s42
    v_mfma_f32_16x16x32_bf16 v[32:35], v[44:47], v[136:139], v[32:35]
    v_mfma_f32_16x16x32_bf16 v[36:39], v[44:47], v[140:143], v[36:39]
    v_mfma_f32_16x16x32_bf16 v[40:43], v[44:47], v[144:147], v[40:43]
    v_perm_b32 v48, v54, v54, v24
    v_perm_b32 v49, v54, v54, v25
    v_perm_b32 v50, v54, v54, v26
    v_perm_b32 v51, v54, v54, v27
    s_waitcnt vmcnt(6)
    s_cmp_gt_i32 s44, 0
    s_cbranch_scc1 bo_23
    s_waitcnt vmcnt(3)
    s_cmp_eq_u32 s44, 0
    s_cbranch_scc1 bc_24
    s_waitcnt vmcnt(1)
    s_add_i32 s44, s44, 2
bo_23:
    s_sub_i32 s44, s44, 1
bc_24:
    buffer_load_dwordx4 v[184:187], v1, s[52:55], s42 offen offset:0 nt
    buffer_load_dwordx4 v[188:191], v1, s[52:55], s42 offen offset:128 nt
    buffer_load_dwordx4 v[192:195], v1, s[52:55], s42 offen offset:256 nt
    s_add_u32 s42, s42, 49152
    s_cmp_ge_u32 s42, s64
    s_cselect_b32 s42, s43, s42
    v_mfma_f32_16x16x32_bf16 v[32:35], v[48:51], v[148:151], v[32:35]
    v_mfma_f32_16x16x32_bf16 v[36:39], v[48:51], v[152:155], v[36:39]
    v_mfma_f32_16x16x32_bf16 v[40:43], v[48:51], v[156:159], v[40:43]
    v_perm_b32 v44, v54, v54, v28
    v_perm_b32 v45, v54, v54, v29
    v_perm_b32 v46, v54, v54, v30
    v_perm_b32 v47, v54, v54, v31
    ds_read_b32 v52, v3
    ds_read_b32 v53, v3 offset:4
    ds_read_b32 v54, v3 offset:8
    v_add_u32 v3, 12, v3
    s_waitcnt vmcnt(6)
    s_cmp_gt_i32 s44, 0
    s_cbranch_scc1 bo_25
    s_waitcnt vmcnt(3)
    s_cmp_eq_u32 s44, 0
    s_cbranch_scc1 bc_26
    s_waitcnt vmcnt(1)
    s_add_i32 s44, s44, 2
bo_25:
    s_sub_i32 s44, s44, 1
bc_26:
    buffer_load_dwordx4 v[196:199], v1, s[52:55], s42 offen offset:0 nt
    buffer_load_dwordx4 v[200:203], v1, s[52:55], s42 offen offset:128 nt
    buffer_load_dwordx4 v[204:207], v1, s[52:55], s42 offen offset:256 nt
    s_add_u32 s42, s42, 49152
    s_cmp_ge_u32 s42, s64
    s_cselect_b32 s42, s43, s42
    v_mfma_f32_16x16x32_bf16 v[32:35], v[44:47], v[160:163], v[32:35]
    v_mfma_f32_16x16x32_bf16 v[36:39], v[44:47], v[164:167], v[36:39]
    v_mfma_f32_16x16x32_bf16 v[40:43], v[44:47], v[168:171], v[40:43]
    s_waitcnt lgkmcnt(0)
    v_perm_b32 v48, v52, v52, v24
    v_perm_b32 v49, v52, v52, v25
    v_perm_b32 v50, v52, v52, v26
    v_perm_b32 v51, v52, v52, v27
    s_waitcnt vmcnt(6)
    buffer_load_dwordx4 v[208:211], v1, s[52:55], s42 offen offset:0 nt
    buffer_load_dwordx4 v[212:215], v1, s[52:55], s42 offen offset:128 nt
    buffer_load_dwordx4 v[216:219], v1, s[52:55], s42 offen offset:256 nt
    s_add_u32 s42, s42, 49152
    s_cmp_ge_u32 s42, s64
    s_cselect_b32 s42, s43, s42
    v_mfma_f32_16x16x32_bf16 v[32:35], v[48:51], v[172:175], v[32:35]
    v_mfma_f32_16x16x32_bf16 v[36:39], v[48:51], v[176:179], v[36:39]
    v_mfma_f32_16x16x32_bf16 v[40:43], v[48:51], v[180:183], v[40:43]
    v_perm_b32 v44, v52, v52, v28
    v_perm_b32 v45, v52, v52, v29
    v_perm_b32 v46, v52, v52, v30
    v_perm_b32 v47, v52, v52, v31
    s_waitcnt vmcnt(6)
    buffer_load_dwordx4 v[220:223], v1, s[52:55], s42 offen offset:0 nt
    buffer_load_dwordx4 v[224:227], v1, s[52:55], s42 offen offset:128 nt
    buffer_load_dwordx4 v[228:231], v1, s[52:55], s42 offen offset:256 nt
    s_add_u32 s42, s42, 49152
    s_cmp_ge_u32 s42, s64
    s_cselect_b32 s42, s43, s42
    v_mfma_f32_16x16x32_bf16 v[32:35], v[44:47], v[184:187], v[32:35]
    v_mfma_f32_16x16x32_bf16 v[36:39], v[44:47], v[188:191], v[36:39]
    v_mfma_f32_16x16x32_bf16 v[40:43], v[44:47], v[192:195], v[40:43]
    v_perm_b32 v48, v53, v53, v24
    v_perm_b32 v49, v53, v53, v25
    v_perm_b32 v50, v53, v53, v26
    v_perm_b32 v51, v53, v53, v27
    s_waitcnt vmcnt(6)
    buffer_load_dwordx4 v[232:235], v1, s[52:55], s42 offen offset:0 nt
    buffer_load_dwordx4 v[236:239], v1, s[52:55], s42 offen offset:128 nt
    buffer_load_dwordx4 v[240:243], v1, s[52:55], s42 offen offset:256 nt
    s_add_u32 s42, s42, 49152
    s_cmp_ge_u32 s42, s64
    s_cselect_b32 s42, s43, s42
    v_mfma_f32_16x16x32_bf16 v[32:35], v[48:51], v[196:199], v[32:35]
    v_mfma_f32_16x16x32_bf16 v[36:39], v[48:51], v[200:203], v[36:39]
    v_mfma_f32_16x16x32_bf16 v[40:43], v[48:51], v[204:207], v[40:43]
    v_perm_b32 v44, v53, v53, v28
    v_perm_b32 v45, v53, v53, v29
    v_perm_b32 v46, v53, v53, v30
    v_perm_b32 v47, v53, v53, v31
    s_waitcnt vmcnt(6)
    s_nop 0
    v_mfma_f32_16x16x32_bf16 v[32:35], v[44:47], v[208:211], v[32:35]
    v_mfma_f32_16x16x32_bf16 v[36:39], v[44:47], v[212:215], v[36:39]
    v_mfma_f32_16x16x32_bf16 v[40:43], v[44:47], v[216:219], v[40:43]
    v_perm_b32 v48, v54, v54, v24
    v_perm_b32 v49, v54, v54, v25
    v_perm_b32 v50, v54, v54, v26
    v_perm_b32 v51, v54, v54, v27
    s_waitcnt vmcnt(3)
    s_nop 0
    v_mfma_f32_16x16x32_bf16 v[32:35], v[48:51], v[220:223], v[32:35]
    v_mfma_f32_16x16x32_bf16 v[36:39], v[48:51], v[224:227], v[36:39]
    v_mfma_f32_16x16x32_bf16 v[40:43], v[48:51], v[228:231], v[40:43]
    v_perm_b32 v44, v54, v54, v28
    v_perm_b32 v45, v54, v54, v29
    v_perm_b32 v46, v54, v54, v30
    v_perm_b32 v47, v54, v54, v31
    s_waitcnt vmcnt(0)
    s_nop 0
    v_mfma_f32_16x16x32_bf16 v[32:35], v[44:47], v[232:235], v[32:35]
    v_mfma_f32_16x16x32_bf16 v[36:39], v[44:47], v[236:239], v[36:39]
    v_mfma_f32_16x16x32_bf16 v[40:43], v[44:47], v[240:243], v[40:43]
    s_nop 3
    s_mov_b32 exec_lo, 0x00ff00ff
    s_mov_b32 exec_hi, 0xff00ff00
    v_cvt_pk_bf16_f32 v12, v32, v33
    v_cvt_pk_bf16_f32 v13, v34, v35
    ds_write2_b32 v8, v12, v13 offset0:0 offset1:48
    v_cvt_pk_bf16_f32 v14, v36, v37
    v_cvt_pk_bf16_f32 v15, v38, v39
    ds_write2_b32 v8, v14, v15 offset0:16 offset1:64
    v_cvt_pk_bf16_f32 v16, v40, v41
    v_cvt_pk_bf16_f32 v17, v42, v43
    ds_write2_b32 v8, v16, v17 offset0:32 offset1:80
    s_mov_b64 exec, -1
    v_mov_b32 v20, 0
    v_mov_b32 v21, 0
    v_mov_b32 v22, 0
    v_mov_b32 v23, 0
    v_mov_b32 v52, 0
    v_mov_b32 v53, 0
    v_mov_b32 v54, 0
    v_mov_b32 v55, 0
    s_waitcnt lgkmcnt(0)
    s_barrier
    ds_read_b128 v[136:139], v4 offset:7680
    ds_read_b128 v[160:163], v5 offset:0
    ds_read_b128 v[164:167], v5 offset:8320
    ds_read_b128 v[168:171], v5 offset:32
    ds_read_b128 v[172:175], v5 offset:8352
    ds_read_b128 v[140:143], v4 offset:7744
    ds_read_b128 v[176:179], v5 offset:16640
    ds_read_b128 v[180:183], v5 offset:24960
    ds_read_b128 v[184:187], v5 offset:16672
    ds_read_b128 v[188:191], v5 offset:24992
    s_waitcnt lgkmcnt(5)
    ds_read_b128 v[144:147], v4 offset:7808
    ds_read_b128 v[192:195], v5 offset:33280
    ds_read_b128 v[196:199], v5 offset:41600
    ds_read_b128 v[200:203], v5 offset:33312
    ds_read_b128 v[204:207], v5 offset:41632
    ds_read_b64 v[40:41], v6 offset:11008
    s_waitcnt lgkmcnt(11)
    v_smfmac_f32_16x16x64_bf16 v[20:23], v[136:139], v[160:167], v18
    v_smfmac_f32_16x16x64_bf16 v[52:55], v[136:139], v[168:175], v18
    s_waitcnt lgkmcnt(6)
    v_smfmac_f32_16x16x64_bf16 v[20:23], v[140:143], v[176:183], v18
    v_smfmac_f32_16x16x64_bf16 v[52:55], v[140:143], v[184:191], v18
    s_waitcnt lgkmcnt(1)
    v_smfmac_f32_16x16x64_bf16 v[20:23], v[144:147], v[192:199], v18
    v_smfmac_f32_16x16x64_bf16 v[52:55], v[144:147], v[200:207], v18
    s_waitcnt lgkmcnt(0)
    s_nop 7
    v_add_f32 v20, v20, v21
    v_add_f32 v22, v22, v23
    v_mul_f32 v20, v20, v40
    v_fmac_f32 v20, v22, v41
    v_add_f32 v52, v52, v53
    v_add_f32 v54, v54, v55
    v_mul_f32 v52, v52, v40
    v_fmac_f32 v52, v54, v41
    s_nop 1
    v_permlane16_swap_b32 v20, v52
    s_nop 1
    v_add_f32 v20, v20, v52
    v_mov_b32 v52, v20
    s_nop 1
    v_permlane32_swap_b32 v20, v52
    s_nop 1
    v_add_f32 v20, v20, v52
    v_add_u32 v20, 2048, v20
    v_and_or_b32 v20, v20, s79, v11
    s_mov_b32 exec_hi, 0
    s_nop 0
    v_mov_b32_dpp v21, v20 quad_perm:[1,1,1,1] row_mask:0xf bank_mask:0xf
    v_mov_b32_dpp v22, v20 quad_perm:[2,2,2,2] row_mask:0xf bank_mask:0xf
    v_mov_b32_dpp v23, v20 quad_perm:[3,3,3,3] row_mask:0xf bank_mask:0xf
    s_mov_b32 exec_lo, 0x11111111
    buffer_store_dwordx4 v[20:23], v7, s[56:59], s67 offen sc1
    s_mov_b64 exec, -1
    s_endpgm
L_H:
    s_setprio 3
    s_sub_u32 s3, s3, 4
    s_and_b32 s14, s10, 7
    s_lshl_b32 s52, s14, 5
    s_add_u32 s52, s52, s4
    s_cmp_ge_u32 s14, 6
    s_cselect_b32 s52, 255, s52
    s_cmp_eq_u32 s3, 3
    s_cbranch_scc1 L_h3
    v_lshrrev_b32 v1, 5, v0
    v_mul_u32_u24 v1, 1280, v1
    v_and_b32 v2, 31, v0
    v_lshl_add_u32 v1, v2, 3, v1
    v_lshrrev_b32 v2, 3, v0
    v_and_b32 v3, 7, v0
    s_lshl_b32 s53, s4, 1
    s_add_u32 s53, s53, s14
    s_sub_u32 s53, s53, 6
    s_lshl_b32 s53, s53, 1
    s_add_u32 s53, s53, s3
    s_add_u32 s9, s52, 128
    s_cmp_eq_u32 s3, 2
    s_cselect_b32 s53, s9, s53
    s_cselect_b32 s9, 7, s14
    s_waitcnt lgkmcnt(0)
    s_mov_b32 s60, s16
    s_mov_b32 s61, s17
    s_mov_b32 s62, 2560
    s_mov_b32 s63, 0x20000
    buffer_load_dwordx2 v[8:9], v1, s[60:63], 0 offen offset:0
    buffer_load_dwordx2 v[10:11], v1, s[60:63], 0 offen offset:256
    buffer_load_dwordx2 v[12:13], v1, s[60:63], 0 offen offset:512
    buffer_load_dwordx2 v[14:15], v1, s[60:63], 0 offen offset:768
    buffer_load_dwordx2 v[16:17], v1, s[60:63], 0 offen offset:1024
    s_mov_b32 s47, 0x20000
    s_cmp_ge_u32 s9, 6
    s_cbranch_scc1 L_jgu
    s_mov_b32 s44, s22
    s_mov_b32 s45, s23
    s_mov_b32 s46, 7864320
    s_mov_b32 s54, 12288
    s_and_b32 s55, s14, 1
    s_lshl_b32 s55, s55, 1
    s_add_u32 s55, s55, s3
    s_lshr_b32 s11, s14, 1
    s_mul_i32 s64, s4, 384
    s_lshl_b32 s9, s11, 7
    s_add_u32 s64, s64, s9
    s_lshl_b32 s66, s4, 2
    s_add_u32 s66, s66, s55
    s_mul_i32 s66, s66, 1536
    s_lshl_b32 s9, s11, 8
    s_add_u32 s66, s66, s9
    s_add_u32 s66, s66, 733440
    s_mov_b32 s13, 768
    s_branch L_jd
L_jgu:
    s_bitcmp1_b32 s53, 2
    s_cselect_b32 s44, s32, s30
    s_cselect_b32 s45, s33, s31
    s_mov_b32 s46, 1966080
    s_mov_b32 s54, 3072
    s_and_b32 s55, s53, 3
    s_lshr_b32 s64, s53, 3
    s_lshl_b32 s64, s64, 7
    s_lshl_b32 s66, s53, 9
    s_add_u32 s66, s66, 930048
    s_mov_b32 s13, 256
L_jd:
    s_mul_i32 s9, s54, 20
    v_mul_lo_u32 v7, v2, s9
    v_lshl_add_u32 v7, v3, 4, v7
    s_mul_i32 s9, s55, 160
    s_mul_i32 s9, s9, s54
    s_add_u32 s9, s9, s64
    v_add_u32 v7, s9, v7
    s_cmp_eq_u32 s3, 2
    s_cbranch_scc1 L_nj1
    s_mov_b32 s9, 0
    buffer_load_dwordx4 v[64:67], v7, s[44:47], s9 offen nt
    s_add_u32 s9, s9, s54
    buffer_load_dwordx4 v[68:71], v7, s[44:47], s9 offen nt
    s_add_u32 s9, s9, s54
    buffer_load_dwordx4 v[72:75], v7, s[44:47], s9 offen nt
    s_add_u32 s9, s9, s54
    buffer_load_dwordx4 v[76:79], v7, s[44:47], s9 offen nt
    s_add_u32 s9, s9, s54
    buffer_load_dwordx4 v[80:83], v7, s[44:47], s9 offen nt
    s_add_u32 s9, s9, s54
    buffer_load_dwordx4 v[84:87], v7, s[44:47], s9 offen nt
    s_add_u32 s9, s9, s54
    buffer_load_dwordx4 v[88:91], v7, s[44:47], s9 offen nt
    s_add_u32 s9, s9, s54
    buffer_load_dwordx4 v[92:95], v7, s[44:47], s9 offen nt
    s_add_u32 s9, s9, s54
    buffer_load_dwordx4 v[96:99], v7, s[44:47], s9 offen nt
    s_add_u32 s9, s9, s54
    buffer_load_dwordx4 v[100:103], v7, s[44:47], s9 offen nt
    s_add_u32 s9, s9, s54
    buffer_load_dwordx4 v[104:107], v7, s[44:47], s9 offen nt
    s_add_u32 s9, s9, s54
    buffer_load_dwordx4 v[108:111], v7, s[44:47], s9 offen nt
    s_add_u32 s9, s9, s54
    buffer_load_dwordx4 v[112:115], v7, s[44:47], s9 offen nt
    s_add_u32 s9, s9, s54
    buffer_load_dwordx4 v[116:119], v7, s[44:47], s9 offen nt
    s_add_u32 s9, s9, s54
    buffer_load_dwordx4 v[120:123], v7, s[44:47], s9 offen nt
    s_add_u32 s9, s9, s54
    buffer_load_dwordx4 v[124:127], v7, s[44:47], s9 offen nt
    s_add_u32 s9, s9, s54
    buffer_load_dwordx4 v[128:131], v7, s[44:47], s9 offen nt
    s_add_u32 s9, s9, s54
    buffer_load_dwordx4 v[132:135], v7, s[44:47], s9 offen nt
    s_add_u32 s9, s9, s54
    buffer_load_dwordx4 v[136:139], v7, s[44:47], s9 offen nt
    s_add_u32 s9, s9, s54
    buffer_load_dwordx4 v[140:143], v7, s[44:47], s9 offen nt
L_nj1:
    s_load_dword s78, s[40:41], 671744
    s_mov_b32 s56, s40
    s_mov_b32 s57, s41
    s_mov_b32 s58, 4194304
    s_mov_b32 s59, 0x20000
    v_and_b32 v4, 1, v0
    v_cmp_eq_u32 vcc, 1, v4
    v_mov_b32 v4, 0x0c0c0100
    v_mov_b32 v5, 0x01000c0c
    v_cndmask_b32 v4, v4, v5, vcc
    v_mov_b32 v5, 0x0c0c0302
    v_mov_b32 v6, 0x03020c0c
    v_cndmask_b32 v5, v5, v6, vcc
    v_bfe_u32 v6, v0, 1, 2
    v_cmp_eq_u32 vcc, 0, v6
    v_mov_b32 v18, 0x0c0c0c0c
    v_mov_b32 v22, 0x0c0c0c0c
    v_cndmask_b32 v18, v18, v4, vcc
    v_cndmask_b32 v22, v22, v5, vcc
    v_cmp_eq_u32 vcc, 1, v6
    v_mov_b32 v19, 0x0c0c0c0c
    v_mov_b32 v23, 0x0c0c0c0c
    v_cndmask_b32 v19, v19, v4, vcc
    v_cndmask_b32 v23, v23, v5, vcc
    v_cmp_eq_u32 vcc, 2, v6
    v_mov_b32 v20, 0x0c0c0c0c
    v_mov_b32 v24, 0x0c0c0c0c
    v_cndmask_b32 v20, v20, v4, vcc
    v_cndmask_b32 v24, v24, v5, vcc
    v_cmp_eq_u32 vcc, 3, v6
    v_mov_b32 v21, 0x0c0c0c0c
    v_mov_b32 v25, 0x0c0c0c0c
    v_cndmask_b32 v21, v21, v4, vcc
    v_cndmask_b32 v25, v25, v5, vcc
    s_cmp_lg_u32 s3, 2
    s_cbranch_scc1 L_nx2
    s_waitcnt vmcnt(0)
L_nx2:
    s_mov_b32 s9, 0x3f803f80
    s_waitcnt vmcnt(20)
    v_dot2_f32_bf16 v4, v8, s9, 0
    v_dot2_f32_bf16 v4, v9, s9, v4
    v_dot2_f32_bf16 v4, v10, s9, v4
    v_dot2_f32_bf16 v4, v11, s9, v4
    v_dot2_f32_bf16 v4, v12, s9, v4
    v_dot2_f32_bf16 v4, v13, s9, v4
    v_dot2_f32_bf16 v4, v14, s9, v4
    v_dot2_f32_bf16 v4, v15, s9, v4
    v_dot2_f32_bf16 v4, v16, s9, v4
    v_dot2_f32_bf16 v4, v17, s9, v4
    v_lshlrev_b32 v28, 16, v8
    v_and_b32 v29, 0xffff0000, v8
    v_lshlrev_b32 v30, 16, v9
    v_and_b32 v31, 0xffff0000, v9
    v_add_f32_dpp v4, v4, v4 row_ror:1 row_mask:0xf bank_mask:0xf
    v_lshlrev_b32 v32, 16, v10
    v_and_b32 v33, 0xffff0000, v10
    v_add_f32_dpp v4, v4, v4 row_ror:2 row_mask:0xf bank_mask:0xf
    v_lshlrev_b32 v34, 16, v11
    v_and_b32 v35, 0xffff0000, v11
    v_add_f32_dpp v4, v4, v4 row_ror:4 row_mask:0xf bank_mask:0xf
    v_lshlrev_b32 v36, 16, v12
    v_and_b32 v37, 0xffff0000, v12
    v_add_f32_dpp v4, v4, v4 row_ror:8 row_mask:0xf bank_mask:0xf
    v_lshlrev_b32 v38, 16, v13
    v_and_b32 v39, 0xffff0000, v13
    v_mov_b32 v5, v4
    v_lshlrev_b32 v40, 16, v14
    v_and_b32 v41, 0xffff0000, v14
    v_permlane16_swap_b32 v4, v5
    v_lshlrev_b32 v42, 16, v15
    v_and_b32 v43, 0xffff0000, v15
    v_lshlrev_b32 v44, 16, v16
    v_and_b32 v45, 0xffff0000, v16
    v_lshlrev_b32 v46, 16, v17
    v_and_b32 v47, 0xffff0000, v17
    v_add_f32 v4, v4, v5
    v_mul_f32 v52, 0x3acccccd, v4
    v_fmac_f32 v4, 0xc4200000, v52
    v_fmac_f32 v52, 0x3acccccd, v4
    v_mov_b32 v53, v52
    v_pk_add_f32 v[54:55], v[28:29], v[52:53] neg_lo:[0,1] neg_hi:[0,1]
    v_pk_mul_f32 v[56:57], v[54:55], v[54:55]
    v_pk_add_f32 v[54:55], v[30:31], v[52:53] neg_lo:[0,1] neg_hi:[0,1]
    v_pk_fma_f32 v[56:57], v[54:55], v[54:55], v[56:57]
    v_pk_add_f32 v[54:55], v[32:33], v[52:53] neg_lo:[0,1] neg_hi:[0,1]
    v_pk_fma_f32 v[56:57], v[54:55], v[54:55], v[56:57]
    v_pk_add_f32 v[54:55], v[34:35], v[52:53] neg_lo:[0,1] neg_hi:[0,1]
    v_pk_fma_f32 v[56:57], v[54:55], v[54:55], v[56:57]
    v_pk_add_f32 v[54:55], v[36:37], v[52:53] neg_lo:[0,1] neg_hi:[0,1]
    v_pk_fma_f32 v[56:57], v[54:55], v[54:55], v[56:57]
    v_pk_add_f32 v[54:55], v[38:39], v[52:53] neg_lo:[0,1] neg_hi:[0,1]
    v_pk_fma_f32 v[56:57], v[54:55], v[54:55], v[56:57]
    v_pk_add_f32 v[54:55], v[40:41], v[52:53] neg_lo:[0,1] neg_hi:[0,1]
    v_pk_fma_f32 v[56:57], v[54:55], v[54:55], v[56:57]
    v_pk_add_f32 v[54:55], v[42:43], v[52:53] neg_lo:[0,1] neg_hi:[0,1]
    v_pk_fma_f32 v[56:57], v[54:55], v[54:55], v[56:57]
    v_pk_add_f32 v[54:55], v[44:45], v[52:53] neg_lo:[0,1] neg_hi:[0,1]
    v_pk_fma_f32 v[56:57], v[54:55], v[54:55], v[56:57]
    v_pk_add_f32 v[54:55], v[46:47], v[52:53] neg_lo:[0,1] neg_hi:[0,1]
    v_pk_fma_f32 v[56:57], v[54:55], v[54:55], v[56:57]
    v_add_f32 v5, v56, v57
    v_cvt_pk_bf16_f32 v52, v52, v52
    v_lshlrev_b32 v52, 16, v52
    v_mov_b32 v53, v52
    v_add_f32_dpp v5, v5, v5 row_ror:1 row_mask:0xf bank_mask:0xf
    v_pk_add_f32 v[28:29], v[28:29], v[52:53] neg_lo:[0,1] neg_hi:[0,1]
    v_cvt_pk_bf16_f32 v29, v28, v29
    v_lshlrev_b32 v28, 16, v29
    v_and_b32 v29, 0xffff0000, v29
    v_add_f32_dpp v5, v5, v5 row_ror:2 row_mask:0xf bank_mask:0xf
    v_pk_add_f32 v[30:31], v[30:31], v[52:53] neg_lo:[0,1] neg_hi:[0,1]
    v_cvt_pk_bf16_f32 v31, v30, v31
    v_lshlrev_b32 v30, 16, v31
    v_and_b32 v31, 0xffff0000, v31
    v_add_f32_dpp v5, v5, v5 row_ror:4 row_mask:0xf bank_mask:0xf
    v_pk_add_f32 v[32:33], v[32:33], v[52:53] neg_lo:[0,1] neg_hi:[0,1]
    v_cvt_pk_bf16_f32 v33, v32, v33
    v_lshlrev_b32 v32, 16, v33
    v_and_b32 v33, 0xffff0000, v33
    v_add_f32_dpp v5, v5, v5 row_ror:8 row_mask:0xf bank_mask:0xf
    v_pk_add_f32 v[34:35], v[34:35], v[52:53] neg_lo:[0,1] neg_hi:[0,1]
    v_cvt_pk_bf16_f32 v35, v34, v35
    v_lshlrev_b32 v34, 16, v35
    v_and_b32 v35, 0xffff0000, v35
    v_mov_b32 v6, v5
    v_pk_add_f32 v[36:37], v[36:37], v[52:53] neg_lo:[0,1] neg_hi:[0,1]
    v_cvt_pk_bf16_f32 v37, v36, v37
    v_lshlrev_b32 v36, 16, v37
    v_and_b32 v37, 0xffff0000, v37
    v_permlane16_swap_b32 v5, v6
    v_pk_add_f32 v[38:39], v[38:39], v[52:53] neg_lo:[0,1] neg_hi:[0,1]
    v_cvt_pk_bf16_f32 v39, v38, v39
    v_lshlrev_b32 v38, 16, v39
    v_and_b32 v39, 0xffff0000, v39
    v_add_f32 v5, v5, v6
    v_mul_f32 v6, 0x3acccccd, v5
    v_fmac_f32 v5, 0xc4200000, v6
    v_fmac_f32 v6, 0x3acccccd, v5
    v_cvt_pk_bf16_f32 v6, v6, v6
    v_lshlrev_b32 v6, 16, v6
    v_add_f32 v6, 0x3727c5ac, v6
    v_cvt_pk_bf16_f32 v6, v6, v6
    v_lshlrev_b32 v6, 16, v6
    v_sqrt_f32 v6, v6
    v_pk_add_f32 v[40:41], v[40:41], v[52:53] neg_lo:[0,1] neg_hi:[0,1]
    v_cvt_pk_bf16_f32 v41, v40, v41
    v_lshlrev_b32 v40, 16, v41
    v_and_b32 v41, 0xffff0000, v41
    v_cvt_pk_bf16_f32 v6, v6, v6
    v_lshlrev_b32 v6, 16, v6
    v_rcp_f32 v54, v6
    v_pk_add_f32 v[42:43], v[42:43], v[52:53] neg_lo:[0,1] neg_hi:[0,1]
    v_cvt_pk_bf16_f32 v43, v42, v43
    v_lshlrev_b32 v42, 16, v43
    v_and_b32 v43, 0xffff0000, v43
    v_mov_b32 v55, v54
    v_mov_b32 v56, v6
    v_mov_b32 v57, v6
    v_pk_add_f32 v[44:45], v[44:45], v[52:53] neg_lo:[0,1] neg_hi:[0,1]
    v_cvt_pk_bf16_f32 v45, v44, v45
    v_lshlrev_b32 v44, 16, v45
    v_and_b32 v45, 0xffff0000, v45
    v_pk_add_f32 v[46:47], v[46:47], v[52:53] neg_lo:[0,1] neg_hi:[0,1]
    v_cvt_pk_bf16_f32 v47, v46, v47
    v_lshlrev_b32 v46, 16, v47
    v_and_b32 v47, 0xffff0000, v47
    v_pk_mul_f32 v[58:59], v[28:29], v[54:55]
    v_pk_fma_f32 v[28:29], v[58:59], v[56:57], v[28:29] neg_lo:[1,0,0] neg_hi:[1,0,0]
    v_pk_fma_f32 v[58:59], v[28:29], v[54:55], v[58:59]
    v_cvt_pk_bf16_f32 v8, v58, v59
    v_pk_mul_f32 v[58:59], v[30:31], v[54:55]
    v_pk_fma_f32 v[30:31], v[58:59], v[56:57], v[30:31] neg_lo:[1,0,0] neg_hi:[1,0,0]
    v_pk_fma_f32 v[58:59], v[30:31], v[54:55], v[58:59]
    v_cvt_pk_bf16_f32 v9, v58, v59
    ds_write_b64 v1, v[8:9] offset:0
    v_pk_mul_f32 v[58:59], v[32:33], v[54:55]
    v_pk_fma_f32 v[32:33], v[58:59], v[56:57], v[32:33] neg_lo:[1,0,0] neg_hi:[1,0,0]
    v_pk_fma_f32 v[58:59], v[32:33], v[54:55], v[58:59]
    v_cvt_pk_bf16_f32 v10, v58, v59
    v_pk_mul_f32 v[58:59], v[34:35], v[54:55]
    v_pk_fma_f32 v[34:35], v[58:59], v[56:57], v[34:35] neg_lo:[1,0,0] neg_hi:[1,0,0]
    v_pk_fma_f32 v[58:59], v[34:35], v[54:55], v[58:59]
    v_cvt_pk_bf16_f32 v11, v58, v59
    ds_write_b64 v1, v[10:11] offset:256
    v_pk_mul_f32 v[58:59], v[36:37], v[54:55]
    v_pk_fma_f32 v[36:37], v[58:59], v[56:57], v[36:37] neg_lo:[1,0,0] neg_hi:[1,0,0]
    v_pk_fma_f32 v[58:59], v[36:37], v[54:55], v[58:59]
    v_cvt_pk_bf16_f32 v12, v58, v59
    v_pk_mul_f32 v[58:59], v[38:39], v[54:55]
    v_pk_fma_f32 v[38:39], v[58:59], v[56:57], v[38:39] neg_lo:[1,0,0] neg_hi:[1,0,0]
    v_pk_fma_f32 v[58:59], v[38:39], v[54:55], v[58:59]
    v_cvt_pk_bf16_f32 v13, v58, v59
    ds_write_b64 v1, v[12:13] offset:512
    v_pk_mul_f32 v[58:59], v[40:41], v[54:55]
    v_pk_fma_f32 v[40:41], v[58:59], v[56:57], v[40:41] neg_lo:[1,0,0] neg_hi:[1,0,0]
    v_pk_fma_f32 v[58:59], v[40:41], v[54:55], v[58:59]
    v_cvt_pk_bf16_f32 v14, v58, v59
    v_pk_mul_f32 v[58:59], v[42:43], v[54:55]
    v_pk_fma_f32 v[42:43], v[58:59], v[56:57], v[42:43] neg_lo:[1,0,0] neg_hi:[1,0,0]
    v_pk_fma_f32 v[58:59], v[42:43], v[54:55], v[58:59]
    v_cvt_pk_bf16_f32 v15, v58, v59
    ds_write_b64 v1, v[14:15] offset:768
    v_pk_mul_f32 v[58:59], v[44:45], v[54:55]
    v_pk_fma_f32 v[44:45], v[58:59], v[56:57], v[44:45] neg_lo:[1,0,0] neg_hi:[1,0,0]
    v_pk_fma_f32 v[58:59], v[44:45], v[54:55], v[58:59]
    v_cvt_pk_bf16_f32 v16, v58, v59
    v_pk_mul_f32 v[58:59], v[46:47], v[54:55]
    v_pk_fma_f32 v[46:47], v[58:59], v[56:57], v[46:47] neg_lo:[1,0,0] neg_hi:[1,0,0]
    v_pk_fma_f32 v[58:59], v[46:47], v[54:55], v[58:59]
    v_cvt_pk_bf16_f32 v17, v58, v59
    ds_write_b64 v1, v[16:17] offset:1024
    s_waitcnt lgkmcnt(0)
    s_lshr_b32 s9, s0, 4
    s_lshl_b32 s9, s9, 8
    s_add_u32 s78, s78, s9
    s_add_u32 s78, s78, 1
    s_mul_i32 s9, s78, 0x9e3779b1
    s_and_b32 s96, s78, 15
    s_bfe_u32 s97, s9, 0x40014
    s_bfe_u32 s98, s9, 0x40018
    s_lshr_b32 s99, s9, 28
    v_mov_b32 v26, 15
    s_cmp_lg_u32 s3, 2
    s_cbranch_scc1 L_job
    s_cmp_ge_u32 s52, 64
    s_cbranch_scc1 L_bar1
    s_mov_b32 s9, 0
    buffer_load_dwordx4 v[64:67], v7, s[44:47], s9 offen nt
    s_add_u32 s9, s9, s54
    buffer_load_dwordx4 v[68:71], v7, s[44:47], s9 offen nt
    s_add_u32 s9, s9, s54
    buffer_load_dwordx4 v[72:75], v7, s[44:47], s9 offen nt
    s_add_u32 s9, s9, s54
    buffer_load_dwordx4 v[76:79], v7, s[44:47], s9 offen nt
    s_add_u32 s9, s9, s54
    buffer_load_dwordx4 v[80:83], v7, s[44:47], s9 offen nt
    s_add_u32 s9, s9, s54
    buffer_load_dwordx4 v[84:87], v7, s[44:47], s9 offen nt
    s_add_u32 s9, s9, s54
    buffer_load_dwordx4 v[88:91], v7, s[44:47], s9 offen nt
    s_add_u32 s9, s9, s54
    buffer_load_dwordx4 v[92:95], v7, s[44:47], s9 offen nt
    s_add_u32 s9, s9, s54
    buffer_load_dwordx4 v[96:99], v7, s[44:47], s9 offen nt
    s_add_u32 s9, s9, s54
    buffer_load_dwordx4 v[100:103], v7, s[44:47], s9 offen nt
    s_add_u32 s9, s9, s54
    buffer_load_dwordx4 v[104:107], v7, s[44:47], s9 offen nt
    s_add_u32 s9, s9, s54
    buffer_load_dwordx4 v[108:111], v7, s[44:47], s9 offen nt
    s_add_u32 s9, s9, s54
    buffer_load_dwordx4 v[112:115], v7, s[44:47], s9 offen nt
    s_add_u32 s9, s9, s54
    buffer_load_dwordx4 v[116:119], v7, s[44:47], s9 offen nt
    s_add_u32 s9, s9, s54
    buffer_load_dwordx4 v[120:123], v7, s[44:47], s9 offen nt
    s_add_u32 s9, s9, s54
    buffer_load_dwordx4 v[124:127], v7, s[44:47], s9 offen nt
    s_add_u32 s9, s9, s54
    buffer_load_dwordx4 v[128:131], v7, s[44:47], s9 offen nt
    s_add_u32 s9, s9, s54
    buffer_load_dwordx4 v[132:135], v7, s[44:47], s9 offen nt
    s_add_u32 s9, s9, s54
    buffer_load_dwordx4 v[136:139], v7, s[44:47], s9 offen nt
    s_add_u32 s9, s9, s54
    buffer_load_dwordx4 v[140:143], v7, s[44:47], s9 offen nt
L_job:
    v_mul_u32_u24 v4, 40, v2
    s_mul_i32 s9, s55, 320
    v_add_u32 v4, s9, v4
    ds_read_b64 v[8:9], v4 offset:0
    ds_read_b64 v[10:11], v4 offset:8
    ds_read_b64 v[12:13], v4 offset:16
    ds_read_b64 v[14:15], v4 offset:24
    ds_read_b64 v[16:17], v4 offset:32
    ds_read_b64 v[44:45], v4 offset:1280
    ds_read_b64 v[46:47], v4 offset:1288
    ds_read_b64 v[48:49], v4 offset:1296
    ds_read_b64 v[50:51], v4 offset:1304
    ds_read_b64 v[52:53], v4 offset:1312
    v_lshrrev_b32 v5, 5, v0
    v_mul_lo_u32 v5, v5, s13
    v_lshl_add_u32 v5, v3, 5, v5
    v_bfe_u32 v6, v0, 4, 1
    v_lshl_add_u32 v5, v6, 4, v5
    s_waitcnt lgkmcnt(0)
    v_perm_b32 v28, v8, v8, v18
    v_perm_b32 v29, v8, v8, v19
    v_perm_b32 v30, v8, v8, v20
    v_perm_b32 v31, v8, v8, v21
    v_perm_b32 v32, v44, v44, v18
    v_perm_b32 v33, v44, v44, v19
    v_perm_b32 v34, v44, v44, v20
    v_perm_b32 v35, v44, v44, v21
    s_waitcnt vmcnt(19)
    s_nop 0
    v_mfma_f32_16x16x32_bf16 v[36:39], v[28:31], v[64:67], 0
    v_mfma_f32_16x16x32_bf16 v[40:43], v[32:35], v[64:67], 0
    v_perm_b32 v28, v8, v8, v22
    v_perm_b32 v29, v8, v8, v23
    v_perm_b32 v30, v8, v8, v24
    v_perm_b32 v31, v8, v8, v25
    v_perm_b32 v32, v44, v44, v22
    v_perm_b32 v33, v44, v44, v23
    v_perm_b32 v34, v44, v44, v24
    v_perm_b32 v35, v44, v44, v25
    s_waitcnt vmcnt(18)
    s_nop 0
    v_mfma_f32_16x16x32_bf16 v[36:39], v[28:31], v[68:71], v[36:39]
    v_mfma_f32_16x16x32_bf16 v[40:43], v[32:35], v[68:71], v[40:43]
    v_perm_b32 v28, v9, v9, v18
    v_perm_b32 v29, v9, v9, v19
    v_perm_b32 v30, v9, v9, v20
    v_perm_b32 v31, v9, v9, v21
    v_perm_b32 v32, v45, v45, v18
    v_perm_b32 v33, v45, v45, v19
    v_perm_b32 v34, v45, v45, v20
    v_perm_b32 v35, v45, v45, v21
    s_waitcnt vmcnt(17)
    s_nop 0
    v_mfma_f32_16x16x32_bf16 v[36:39], v[28:31], v[72:75], v[36:39]
    v_mfma_f32_16x16x32_bf16 v[40:43], v[32:35], v[72:75], v[40:43]
    v_perm_b32 v28, v9, v9, v22
    v_perm_b32 v29, v9, v9, v23
    v_perm_b32 v30, v9, v9, v24
    v_perm_b32 v31, v9, v9, v25
    v_perm_b32 v32, v45, v45, v22
    v_perm_b32 v33, v45, v45, v23
    v_perm_b32 v34, v45, v45, v24
    v_perm_b32 v35, v45, v45, v25
    s_waitcnt vmcnt(16)
    s_nop 0
    v_mfma_f32_16x16x32_bf16 v[36:39], v[28:31], v[76:79], v[36:39]
    v_mfma_f32_16x16x32_bf16 v[40:43], v[32:35], v[76:79], v[40:43]
    v_perm_b32 v28, v10, v10, v18
    v_perm_b32 v29, v10, v10, v19
    v_perm_b32 v30, v10, v10, v20
    v_perm_b32 v31, v10, v10, v21
    v_perm_b32 v32, v46, v46, v18
    v_perm_b32 v33, v46, v46, v19
    v_perm_b32 v34, v46, v46, v20
    v_perm_b32 v35, v46, v46, v21
    s_waitcnt vmcnt(15)
    s_nop 0
    v_mfma_f32_16x16x32_bf16 v[36:39], v[28:31], v[80:83], v[36:39]
    v_mfma_f32_16x16x32_bf16 v[40:43], v[32:35], v[80:83], v[40:43]
    v_perm_b32 v28, v10, v10, v22
    v_perm_b32 v29, v10, v10, v23
    v_perm_b32 v30, v10, v10, v24
    v_perm_b32 v31, v10, v10, v25
    v_perm_b32 v32, v46, v46, v22
    v_perm_b32 v33, v46, v46, v23
    v_perm_b32 v34, v46, v46, v24
    v_perm_b32 v35, v46, v46, v25
    s_waitcnt vmcnt(14)
    s_nop 0
    v_mfma_f32_16x16x32_bf16 v[36:39], v[28:31], v[84:87], v[36:39]
    v_mfma_f32_16x16x32_bf16 v[40:43], v[32:35], v[84:87], v[40:43]
    v_perm_b32 v28, v11, v11, v18
    v_perm_b32 v29, v11, v11, v19
    v_perm_b32 v30, v11, v11, v20
    v_perm_b32 v31, v11, v11, v21
    v_perm_b32 v32, v47, v47, v18
    v_perm_b32 v33, v47, v47, v19
    v_perm_b32 v34, v47, v47, v20
    v_perm_b32 v35, v47, v47, v21
    s_waitcnt vmcnt(13)
    s_nop 0
    v_mfma_f32_16x16x32_bf16 v[36:39], v[28:31], v[88:91], v[36:39]
    v_mfma_f32_16x16x32_bf16 v[40:43], v[32:35], v[88:91], v[40:43]
    v_perm_b32 v28, v11, v11, v22
    v_perm_b32 v29, v11, v11, v23
    v_perm_b32 v30, v11, v11, v24
    v_perm_b32 v31, v11, v11, v25
    v_perm_b32 v32, v47, v47, v22
    v_perm_b32 v33, v47, v47, v23
    v_perm_b32 v34, v47, v47, v24
    v_perm_b32 v35, v47, v47, v25
    s_waitcnt vmcnt(12)
    s_nop 0
    v_mfma_f32_16x16x32_bf16 v[36:39], v[28:31], v[92:95], v[36:39]
    v_mfma_f32_16x16x32_bf16 v[40:43], v[32:35], v[92:95], v[40:43]
    v_perm_b32 v28, v12, v12, v18
    v_perm_b32 v29, v12, v12, v19
    v_perm_b32 v30, v12, v12, v20
    v_perm_b32 v31, v12, v12, v21
    v_perm_b32 v32, v48, v48, v18
    v_perm_b32 v33, v48, v48, v19
    v_perm_b32 v34, v48, v48, v20
    v_perm_b32 v35, v48, v48, v21
    s_waitcnt vmcnt(11)
    s_nop 0
    v_mfma_f32_16x16x32_bf16 v[36:39], v[28:31], v[96:99], v[36:39]
    v_mfma_f32_16x16x32_bf16 v[40:43], v[32:35], v[96:99], v[40:43]
    v_perm_b32 v28, v12, v12, v22
    v_perm_b32 v29, v12, v12, v23
    v_perm_b32 v30, v12, v12, v24
    v_perm_b32 v31, v12, v12, v25
    v_perm_b32 v32, v48, v48, v22
    v_perm_b32 v33, v48, v48, v23
    v_perm_b32 v34, v48, v48, v24
    v_perm_b32 v35, v48, v48, v25
    s_waitcnt vmcnt(10)
    s_nop 0
    v_mfma_f32_16x16x32_bf16 v[36:39], v[28:31], v[100:103], v[36:39]
    v_mfma_f32_16x16x32_bf16 v[40:43], v[32:35], v[100:103], v[40:43]
    v_perm_b32 v28, v13, v13, v18
    v_perm_b32 v29, v13, v13, v19
    v_perm_b32 v30, v13, v13, v20
    v_perm_b32 v31, v13, v13, v21
    v_perm_b32 v32, v49, v49, v18
    v_perm_b32 v33, v49, v49, v19
    v_perm_b32 v34, v49, v49, v20
    v_perm_b32 v35, v49, v49, v21
    s_waitcnt vmcnt(9)
    s_nop 0
    v_mfma_f32_16x16x32_bf16 v[36:39], v[28:31], v[104:107], v[36:39]
    v_mfma_f32_16x16x32_bf16 v[40:43], v[32:35], v[104:107], v[40:43]
    v_perm_b32 v28, v13, v13, v22
    v_perm_b32 v29, v13, v13, v23
    v_perm_b32 v30, v13, v13, v24
    v_perm_b32 v31, v13, v13, v25
    v_perm_b32 v32, v49, v49, v22
    v_perm_b32 v33, v49, v49, v23
    v_perm_b32 v34, v49, v49, v24
    v_perm_b32 v35, v49, v49, v25
    s_waitcnt vmcnt(8)
    s_nop 0
    v_mfma_f32_16x16x32_bf16 v[36:39], v[28:31], v[108:111], v[36:39]
    v_mfma_f32_16x16x32_bf16 v[40:43], v[32:35], v[108:111], v[40:43]
    v_perm_b32 v28, v14, v14, v18
    v_perm_b32 v29, v14, v14, v19
    v_perm_b32 v30, v14, v14, v20
    v_perm_b32 v31, v14, v14, v21
    v_perm_b32 v32, v50, v50, v18
    v_perm_b32 v33, v50, v50, v19
    v_perm_b32 v34, v50, v50, v20
    v_perm_b32 v35, v50, v50, v21
    s_waitcnt vmcnt(7)
    s_nop 0
    v_mfma_f32_16x16x32_bf16 v[36:39], v[28:31], v[112:115], v[36:39]
    v_mfma_f32_16x16x32_bf16 v[40:43], v[32:35], v[112:115], v[40:43]
    v_perm_b32 v28, v14, v14, v22
    v_perm_b32 v29, v14, v14, v23
    v_perm_b32 v30, v14, v14, v24
    v_perm_b32 v31, v14, v14, v25
    v_perm_b32 v32, v50, v50, v22
    v_perm_b32 v33, v50, v50, v23
    v_perm_b32 v34, v50, v50, v24
    v_perm_b32 v35, v50, v50, v25
    s_waitcnt vmcnt(6)
    s_nop 0
    v_mfma_f32_16x16x32_bf16 v[36:39], v[28:31], v[116:119], v[36:39]
    v_mfma_f32_16x16x32_bf16 v[40:43], v[32:35], v[116:119], v[40:43]
    v_perm_b32 v28, v15, v15, v18
    v_perm_b32 v29, v15, v15, v19
    v_perm_b32 v30, v15, v15, v20
    v_perm_b32 v31, v15, v15, v21
    v_perm_b32 v32, v51, v51, v18
    v_perm_b32 v33, v51, v51, v19
    v_perm_b32 v34, v51, v51, v20
    v_perm_b32 v35, v51, v51, v21
    s_waitcnt vmcnt(5)
    s_nop 0
    v_mfma_f32_16x16x32_bf16 v[36:39], v[28:31], v[120:123], v[36:39]
    v_mfma_f32_16x16x32_bf16 v[40:43], v[32:35], v[120:123], v[40:43]
    v_perm_b32 v28, v15, v15, v22
    v_perm_b32 v29, v15, v15, v23
    v_perm_b32 v30, v15, v15, v24
    v_perm_b32 v31, v15, v15, v25
    v_perm_b32 v32, v51, v51, v22
    v_perm_b32 v33, v51, v51, v23
    v_perm_b32 v34, v51, v51, v24
    v_perm_b32 v35, v51, v51, v25
    s_waitcnt vmcnt(4)
    s_nop 0
    v_mfma_f32_16x16x32_bf16 v[36:39], v[28:31], v[124:127], v[36:39]
    v_mfma_f32_16x16x32_bf16 v[40:43], v[32:35], v[124:127], v[40:43]
    v_perm_b32 v28, v16, v16, v18
    v_perm_b32 v29, v16, v16, v19
    v_perm_b32 v30, v16, v16, v20
    v_perm_b32 v31, v16, v16, v21
    v_perm_b32 v32, v52, v52, v18
    v_perm_b32 v33, v52, v52, v19
    v_perm_b32 v34, v52, v52, v20
    v_perm_b32 v35, v52, v52, v21
    s_waitcnt vmcnt(3)
    s_nop 0
    v_mfma_f32_16x16x32_bf16 v[36:39], v[28:31], v[128:131], v[36:39]
    v_mfma_f32_16x16x32_bf16 v[40:43], v[32:35], v[128:131], v[40:43]
    v_perm_b32 v28, v16, v16, v22
    v_perm_b32 v29, v16, v16, v23
    v_perm_b32 v30, v16, v16, v24
    v_perm_b32 v31, v16, v16, v25
    v_perm_b32 v32, v52, v52, v22
    v_perm_b32 v33, v52, v52, v23
    v_perm_b32 v34, v52, v52, v24
    v_perm_b32 v35, v52, v52, v25
    s_waitcnt vmcnt(2)
    s_nop 0
    v_mfma_f32_16x16x32_bf16 v[36:39], v[28:31], v[132:135], v[36:39]
    v_mfma_f32_16x16x32_bf16 v[40:43], v[32:35], v[132:135], v[40:43]
    v_perm_b32 v28, v17, v17, v18
    v_perm_b32 v29, v17, v17, v19
    v_perm_b32 v30, v17, v17, v20
    v_perm_b32 v31, v17, v17, v21
    v_perm_b32 v32, v53, v53, v18
    v_perm_b32 v33, v53, v53, v19
    v_perm_b32 v34, v53, v53, v20
    v_perm_b32 v35, v53, v53, v21
    s_waitcnt vmcnt(1)
    s_nop 0
    v_mfma_f32_16x16x32_bf16 v[36:39], v[28:31], v[136:139], v[36:39]
    v_mfma_f32_16x16x32_bf16 v[40:43], v[32:35], v[136:139], v[40:43]
    v_perm_b32 v28, v17, v17, v22
    v_perm_b32 v29, v17, v17, v23
    v_perm_b32 v30, v17, v17, v24
    v_perm_b32 v31, v17, v17, v25
    v_perm_b32 v32, v53, v53, v22
    v_perm_b32 v33, v53, v53, v23
    v_perm_b32 v34, v53, v53, v24
    v_perm_b32 v35, v53, v53, v25
    s_waitcnt vmcnt(0)
    s_nop 0
    v_mfma_f32_16x16x32_bf16 v[36:39], v[28:31], v[140:143], v[36:39]
    v_mfma_f32_16x16x32_bf16 v[40:43], v[32:35], v[140:143], v[40:43]
    s_nop 7
    v_permlane32_swap_b32 v36, v40
    v_permlane32_swap_b32 v37, v41
    v_permlane32_swap_b32 v38, v42
    v_permlane32_swap_b32 v39, v43
    s_nop 1
    v_add_f32_dpp v36, v40, v36 row_ror:8 row_mask:0xf bank_mask:0xf
    v_add_f32_dpp v37, v41, v37 row_ror:8 row_mask:0xf bank_mask:0xf
    v_add_f32_dpp v38, v42, v38 row_ror:8 row_mask:0xf bank_mask:0xf
    v_add_f32_dpp v39, v43, v39 row_ror:8 row_mask:0xf bank_mask:0xf
    v_add_u32 v36, 8, v36
    v_bfi_b32 v36, v26, s96, v36
    v_add_u32 v37, 8, v37
    v_bfi_b32 v37, v26, s97, v37
    v_add_u32 v38, 8, v38
    v_bfi_b32 v38, v26, s98, v38
    v_add_u32 v39, 8, v39
    v_bfi_b32 v39, v26, s99, v39
    s_mov_b32 exec_lo, 0x00ff00ff
    s_mov_b32 exec_hi, 0x00ff00ff
    buffer_store_dwordx4 v[36:39], v5, s[56:59], s66 offen sc1
    s_mov_b64 exec, -1
    s_setprio 0
    s_cmp_eq_u32 s3, 2
    s_cbranch_scc1 L_bar1
    s_mov_b32 s44, s24
    s_mov_b32 s45, s25
    s_mov_b32 s46, 7864320
    s_mov_b32 s47, 0x20000
    v_lshrrev_b32 v4, 4, v0
    v_mul_u32_u24 v4, 10240, v4
    v_and_b32 v5, 15, v0
    v_lshl_add_u32 v4, v5, 4, v4
    s_mul_i32 s9, s4, 245760
    s_mul_i32 s10, s3, 122880
    s_add_u32 s9, s9, s10
    s_add_u32 s9, s9, 1024
    v_add_u32 v4, s9, v4
    s_mul_i32 s9, s3, 24960
    s_add_u32 s9, s9, 12288
    v_lshlrev_b32 v5, 4, v0
    v_add_u32 v5, s9, v5
    s_mov_b32 s14, 0x05040100
    s_mov_b32 s15, 0x07060302
    s_mov_b32 s9, 0
    buffer_load_dwordx4 v[64:67], v4, s[44:47], s9 offen offset:0
    buffer_load_dwordx4 v[68:71], v4, s[44:47], s9 offen offset:1280
    buffer_load_dwordx4 v[72:75], v4, s[44:47], s9 offen offset:2560
    buffer_load_dwordx4 v[76:79], v4, s[44:47], s9 offen offset:3840
    s_mov_b32 s9, 5120
    buffer_load_dwordx4 v[80:83], v4, s[44:47], s9 offen offset:0
    buffer_load_dwordx4 v[84:87], v4, s[44:47], s9 offen offset:1280
    buffer_load_dwordx4 v[88:91], v4, s[44:47], s9 offen offset:2560
    buffer_load_dwordx4 v[92:95], v4, s[44:47], s9 offen offset:3840
    s_waitcnt vmcnt(6)
    v_perm_b32 v96, v68, v64, s14
    v_perm_b32 v100, v68, v64, s15
    v_perm_b32 v104, v69, v65, s14
    v_perm_b32 v108, v69, v65, s15
    v_perm_b32 v112, v70, v66, s14
    v_perm_b32 v116, v70, v66, s15
    v_perm_b32 v120, v71, v67, s14
    v_perm_b32 v124, v71, v67, s15
    s_waitcnt vmcnt(4)
    v_perm_b32 v97, v76, v72, s14
    v_perm_b32 v101, v76, v72, s15
    v_perm_b32 v105, v77, v73, s14
    v_perm_b32 v109, v77, v73, s15
    v_perm_b32 v113, v78, v74, s14
    v_perm_b32 v117, v78, v74, s15
    v_perm_b32 v121, v79, v75, s14
    v_perm_b32 v125, v79, v75, s15
    s_waitcnt vmcnt(2)
    v_perm_b32 v98, v84, v80, s14
    v_perm_b32 v102, v84, v80, s15
    v_perm_b32 v106, v85, v81, s14
    v_perm_b32 v110, v85, v81, s15
    v_perm_b32 v114, v86, v82, s14
    v_perm_b32 v118, v86, v82, s15
    v_perm_b32 v122, v87, v83, s14
    v_perm_b32 v126, v87, v83, s15
    s_waitcnt vmcnt(0)
    v_perm_b32 v99, v92, v88, s14
    v_perm_b32 v103, v92, v88, s15
    v_perm_b32 v107, v93, v89, s14
    v_perm_b32 v111, v93, v89, s15
    v_perm_b32 v115, v94, v90, s14
    v_perm_b32 v119, v94, v90, s15
    v_perm_b32 v123, v95, v91, s14
    v_perm_b32 v127, v95, v91, s15
    ds_write_b128 v5, v[96:99] offset:0
    ds_write_b128 v5, v[100:103] offset:1040
    ds_write_b128 v5, v[104:107] offset:2080
    ds_write_b128 v5, v[108:111] offset:3120
    ds_write_b128 v5, v[112:115] offset:4160
    ds_write_b128 v5, v[116:119] offset:5200
    ds_write_b128 v5, v[120:123] offset:6240
    ds_write_b128 v5, v[124:127] offset:7280
    s_mov_b32 s9, 40960
    buffer_load_dwordx4 v[128:131], v4, s[44:47], s9 offen offset:0
    buffer_load_dwordx4 v[132:135], v4, s[44:47], s9 offen offset:1280
    buffer_load_dwordx4 v[136:139], v4, s[44:47], s9 offen offset:2560
    buffer_load_dwordx4 v[140:143], v4, s[44:47], s9 offen offset:3840
    s_mov_b32 s9, 46080
    buffer_load_dwordx4 v[144:147], v4, s[44:47], s9 offen offset:0
    buffer_load_dwordx4 v[148:151], v4, s[44:47], s9 offen offset:1280
    buffer_load_dwordx4 v[152:155], v4, s[44:47], s9 offen offset:2560
    buffer_load_dwordx4 v[156:159], v4, s[44:47], s9 offen offset:3840
    s_waitcnt vmcnt(6)
    v_perm_b32 v160, v132, v128, s14
    v_perm_b32 v164, v132, v128, s15
    v_perm_b32 v168, v133, v129, s14
    v_perm_b32 v172, v133, v129, s15
    v_perm_b32 v176, v134, v130, s14
    v_perm_b32 v180, v134, v130, s15
    v_perm_b32 v184, v135, v131, s14
    v_perm_b32 v188, v135, v131, s15
    s_waitcnt vmcnt(4)
    v_perm_b32 v161, v140, v136, s14
    v_perm_b32 v165, v140, v136, s15
    v_perm_b32 v169, v141, v137, s14
    v_perm_b32 v173, v141, v137, s15
    v_perm_b32 v177, v142, v138, s14
    v_perm_b32 v181, v142, v138, s15
    v_perm_b32 v185, v143, v139, s14
    v_perm_b32 v189, v143, v139, s15
    s_waitcnt vmcnt(2)
    v_perm_b32 v162, v148, v144, s14
    v_perm_b32 v166, v148, v144, s15
    v_perm_b32 v170, v149, v145, s14
    v_perm_b32 v174, v149, v145, s15
    v_perm_b32 v178, v150, v146, s14
    v_perm_b32 v182, v150, v146, s15
    v_perm_b32 v186, v151, v147, s14
    v_perm_b32 v190, v151, v147, s15
    s_waitcnt vmcnt(0)
    v_perm_b32 v163, v156, v152, s14
    v_perm_b32 v167, v156, v152, s15
    v_perm_b32 v171, v157, v153, s14
    v_perm_b32 v175, v157, v153, s15
    v_perm_b32 v179, v158, v154, s14
    v_perm_b32 v183, v158, v154, s15
    v_perm_b32 v187, v159, v155, s14
    v_perm_b32 v191, v159, v155, s15
    ds_write_b128 v5, v[160:163] offset:8320
    ds_write_b128 v5, v[164:167] offset:9360
    ds_write_b128 v5, v[168:171] offset:10400
    ds_write_b128 v5, v[172:175] offset:11440
    ds_write_b128 v5, v[176:179] offset:12480
    ds_write_b128 v5, v[180:183] offset:13520
    ds_write_b128 v5, v[184:187] offset:14560
    ds_write_b128 v5, v[188:191] offset:15600
    s_barrier
    s_mov_b32 s9, 81920
    buffer_load_dwordx4 v[192:195], v4, s[44:47], s9 offen offset:0
    buffer_load_dwordx4 v[196:199], v4, s[44:47], s9 offen offset:1280
    buffer_load_dwordx4 v[200:203], v4, s[44:47], s9 offen offset:2560
    buffer_load_dwordx4 v[204:207], v4, s[44:47], s9 offen offset:3840
    s_mov_b32 s9, 87040
    buffer_load_dwordx4 v[208:211], v4, s[44:47], s9 offen offset:0
    buffer_load_dwordx4 v[212:215], v4, s[44:47], s9 offen offset:1280
    buffer_load_dwordx4 v[216:219], v4, s[44:47], s9 offen offset:2560
    buffer_load_dwordx4 v[220:223], v4, s[44:47], s9 offen offset:3840
    s_waitcnt vmcnt(6)
    v_perm_b32 v224, v196, v192, s14
    v_perm_b32 v228, v196, v192, s15
    v_perm_b32 v232, v197, v193, s14
    v_perm_b32 v236, v197, v193, s15
    v_perm_b32 v240, v198, v194, s14
    v_perm_b32 v244, v198, v194, s15
    v_perm_b32 v248, v199, v195, s14
    v_perm_b32 v252, v199, v195, s15
    s_waitcnt vmcnt(4)
    v_perm_b32 v225, v204, v200, s14
    v_perm_b32 v229, v204, v200, s15
    v_perm_b32 v233, v205, v201, s14
    v_perm_b32 v237, v205, v201, s15
    v_perm_b32 v241, v206, v202, s14
    v_perm_b32 v245, v206, v202, s15
    v_perm_b32 v249, v207, v203, s14
    v_perm_b32 v253, v207, v203, s15
    s_waitcnt vmcnt(2)
    v_perm_b32 v226, v212, v208, s14
    v_perm_b32 v230, v212, v208, s15
    v_perm_b32 v234, v213, v209, s14
    v_perm_b32 v238, v213, v209, s15
    v_perm_b32 v242, v214, v210, s14
    v_perm_b32 v246, v214, v210, s15
    v_perm_b32 v250, v215, v211, s14
    v_perm_b32 v254, v215, v211, s15
    s_waitcnt vmcnt(0)
    v_perm_b32 v227, v220, v216, s14
    v_perm_b32 v231, v220, v216, s15
    v_perm_b32 v235, v221, v217, s14
    v_perm_b32 v239, v221, v217, s15
    v_perm_b32 v243, v222, v218, s14
    v_perm_b32 v247, v222, v218, s15
    v_perm_b32 v251, v223, v219, s14
    v_perm_b32 v255, v223, v219, s15
    ds_write_b128 v5, v[224:227] offset:16640
    ds_write_b128 v5, v[228:231] offset:17680
    ds_write_b128 v5, v[232:235] offset:18720
    ds_write_b128 v5, v[236:239] offset:19760
    ds_write_b128 v5, v[240:243] offset:20800
    ds_write_b128 v5, v[244:247] offset:21840
    ds_write_b128 v5, v[248:251] offset:22880
    ds_write_b128 v5, v[252:255] offset:23920
    s_lshl_b32 s9, s3, 2
    v_mov_b32 v4, s9
    v_mov_b32 v5, 1
    ds_write_b32 v4, v5 offset:11064
    s_waitcnt lgkmcnt(0)
    s_branch L_h1
L_h3:
    v_mov_b32 v10, 0
    v_mov_b32 v11, 0
    s_waitcnt lgkmcnt(0)
    s_load_dword s78, s[40:41], 671744
    s_mov_b32 s56, s40
    s_mov_b32 s57, s41
    s_mov_b32 s58, 4194304
    s_mov_b32 s59, 0x20000
    v_lshlrev_b32 v4, 4, v0
    v_lshlrev_b32 v5, 3, v0
    s_mul_i32 s9, s4, 6144
    s_mul_i32 s11, s5, 768
    s_add_u32 s9, s9, s11
    s_add_u32 s70, s9, 733440
    s_add_u32 s71, s70, 3072
    s_waitcnt lgkmcnt(0)
    s_lshr_b32 s9, s0, 4
    s_lshl_b32 s9, s9, 8
    s_add_u32 s78, s78, s9
    s_add_u32 s78, s78, 1
    s_mul_i32 s9, s78, 0x9e3779b1
    s_and_b32 s96, s78, 15
    s_bfe_u32 s97, s9, 0x40014
    s_bfe_u32 s98, s9, 0x40018
    s_lshr_b32 s99, s9, 28
    v_mov_b32 v26, 15
    v_mov_b32 v6, 0
    s_not_b32 s9, s78
    v_mov_b32 v1, s9
    v_lshlrev_b32 v2, 2, v0
    ds_write_b32 v6, v6 offset:11056
    ds_write_b32 v6, v6 offset:11060
    ds_write_b32 v6, v6 offset:11064
    ds_write_b32 v6, v6 offset:11068
    s_mov_b64 exec, 0xffff
    ds_write_b32 v2, v1 offset:11584
    s_mov_b64 exec, -1
    s_sleep 127
    s_sleep 48
    s_mov_b32 s80, -1
    s_mov_b32 s81, 0xffff
    s_mov_b32 s82, -1
    s_mov_b32 s83, 0xffff
    s_mov_b32 s84, -1
    s_mov_b32 s85, 0xffff
    s_mov_b32 s86, -1
    s_mov_b32 s87, 0xffff
    s_mov_b32 s12, 262144
mp_27:
    s_mov_b64 exec, s[80:81]
    s_cbranch_execz ml_29
    buffer_load_dwordx4 v[64:67], v4, s[56:59], s70 offen offset:0 sc1
ml_29:
    s_mov_b64 exec, s[82:83]
    s_cbranch_execz ml_30
    buffer_load_dwordx4 v[68:71], v4, s[56:59], s70 offen offset:1536 sc1
ml_30:
    s_mov_b64 exec, s[84:85]
    s_cbranch_execz ml_31
    buffer_load_dwordx4 v[72:75], v4, s[56:59], s71 offen offset:0 sc1
ml_31:
    s_mov_b64 exec, s[86:87]
    s_cbranch_execz ml_32
    buffer_load_dwordx4 v[76:79], v4, s[56:59], s71 offen offset:1536 sc1
ml_32:
    s_mov_b64 s[100:101], 0
    s_waitcnt vmcnt(0)
    s_mov_b64 exec, s[80:81]
    s_cbranch_execz mc_33
    v_xor_b32 v64, s96, v64
    v_xor_b32 v65, s97, v65
    v_xor_b32 v66, s98, v66
    v_xor_b32 v67, s99, v67
    v_or_b32 v27, v64, v65
    v_or3_b32 v27, v66, v67, v27
    v_and_b32 v27, 15, v27
    v_cmp_ne_u32 vcc, 0, v27
    s_cmp_lg_u64 vcc, 0
    s_cselect_b64 s[80:81], s[80:81], 0
    s_or_b64 s[100:101], s[100:101], s[80:81]
mc_33:
    s_mov_b64 exec, s[82:83]
    s_cbranch_execz mc_34
    v_xor_b32 v68, s96, v68
    v_xor_b32 v69, s97, v69
    v_xor_b32 v70, s98, v70
    v_xor_b32 v71, s99, v71
    v_or_b32 v27, v68, v69
    v_or3_b32 v27, v70, v71, v27
    v_and_b32 v27, 15, v27
    v_cmp_ne_u32 vcc, 0, v27
    s_cmp_lg_u64 vcc, 0
    s_cselect_b64 s[82:83], s[82:83], 0
    s_or_b64 s[100:101], s[100:101], s[82:83]
mc_34:
    s_mov_b64 exec, s[84:85]
    s_cbranch_execz mc_35
    v_xor_b32 v72, s96, v72
    v_xor_b32 v73, s97, v73
    v_xor_b32 v74, s98, v74
    v_xor_b32 v75, s99, v75
    v_or_b32 v27, v72, v73
    v_or3_b32 v27, v74, v75, v27
    v_and_b32 v27, 15, v27
    v_cmp_ne_u32 vcc, 0, v27
    s_cmp_lg_u64 vcc, 0
    s_cselect_b64 s[84:85], s[84:85], 0
    s_or_b64 s[100:101], s[100:101], s[84:85]
mc_35:
    s_mov_b64 exec, s[86:87]
    s_cbranch_execz mc_36
    v_xor_b32 v76, s96, v76
    v_xor_b32 v77, s97, v77
    v_xor_b32 v78, s98, v78
    v_xor_b32 v79, s99, v79
    v_or_b32 v27, v76, v77
    v_or3_b32 v27, v78, v79, v27
    v_and_b32 v27, 15, v27
    v_cmp_ne_u32 vcc, 0, v27
    s_cmp_lg_u64 vcc, 0
    s_cselect_b64 s[86:87], s[86:87], 0
    s_or_b64 s[100:101], s[100:101], s[86:87]
mc_36:
    s_mov_b64 exec, -1
    s_cmp_eq_u64 s[100:101], 0
    s_cbranch_scc1 mpd_28
    s_sub_u32 s12, s12, 1
    s_cmp_gt_u32 s12, 0
    s_cbranch_scc1 mp_27
mpd_28:
    v_pk_add_f32 v[64:65], v[64:65], v[68:69]
    v_pk_add_f32 v[66:67], v[66:67], v[70:71]
    v_pk_add_f32 v[64:65], v[64:65], v[72:73]
    v_pk_add_f32 v[66:67], v[66:67], v[74:75]
    v_pk_add_f32 v[64:65], v[64:65], v[76:77]
    v_pk_add_f32 v[66:67], v[66:67], v[78:79]
    s_mov_b32 exec_hi, 0xffff
    v_cvt_pk_bf16_f32 v64, v64, v65
    v_cvt_pk_bf16_f32 v65, v66, v67
    ds_write_b64 v5, v[64:65] offset:2560
    s_mov_b64 exec, -1
    s_waitcnt lgkmcnt(0)
L_bar1:
    s_setprio 0
    s_barrier
L_h1:
    v_and_b32 v2, 15, v0
    v_lshrrev_b32 v3, 4, v0
    s_mov_b32 s44, s24
    s_mov_b32 s45, s25
    s_mov_b32 s46, 7864320
    s_mov_b32 s47, 0x20000
    v_mul_u32_u24 v7, 10240, v3
    s_mul_i32 s9, s4, 245760
    v_add_u32 v7, s9, v7
    v_lshl_add_u32 v7, v2, 4, v7
    s_lshl_b32 s9, s3, 8
    v_add_u32 v7, s9, v7
    s_mov_b32 s14, 0x05040100
    s_mov_b32 s15, 0x07060302
    s_mov_b32 s9, 204800
    buffer_load_dwordx4 v[32:35], v7, s[44:47], s9 offen offset:0
    buffer_load_dwordx4 v[36:39], v7, s[44:47], s9 offen offset:1280
    buffer_load_dwordx4 v[40:43], v7, s[44:47], s9 offen offset:2560
    buffer_load_dwordx4 v[44:47], v7, s[44:47], s9 offen offset:3840
    s_waitcnt vmcnt(0)
    s_mov_b32 s9, 209920
    buffer_load_dwordx4 v[48:51], v7, s[44:47], s9 offen offset:0
    buffer_load_dwordx4 v[52:55], v7, s[44:47], s9 offen offset:1280
    buffer_load_dwordx4 v[56:59], v7, s[44:47], s9 offen offset:2560
    buffer_load_dwordx4 v[60:63], v7, s[44:47], s9 offen offset:3840
    s_waitcnt vmcnt(6)
    v_perm_b32 v196, v36, v32, s14
    v_perm_b32 v204, v36, v32, s15
    v_perm_b32 v212, v37, v33, s14
    v_perm_b32 v220, v37, v33, s15
    v_perm_b32 v228, v38, v34, s14
    v_perm_b32 v236, v38, v34, s15
    v_perm_b32 v244, v39, v35, s14
    v_perm_b32 v252, v39, v35, s15
    s_waitcnt vmcnt(4)
    v_perm_b32 v197, v44, v40, s14
    v_perm_b32 v205, v44, v40, s15
    v_perm_b32 v213, v45, v41, s14
    v_perm_b32 v221, v45, v41, s15
    v_perm_b32 v229, v46, v42, s14
    v_perm_b32 v237, v46, v42, s15
    v_perm_b32 v245, v47, v43, s14
    v_perm_b32 v253, v47, v43, s15
    s_waitcnt vmcnt(2)
    v_perm_b32 v198, v52, v48, s14
    v_perm_b32 v206, v52, v48, s15
    v_perm_b32 v214, v53, v49, s14
    v_perm_b32 v222, v53, v49, s15
    v_perm_b32 v230, v54, v50, s14
    v_perm_b32 v238, v54, v50, s15
    v_perm_b32 v246, v55, v51, s14
    v_perm_b32 v254, v55, v51, s15
    s_waitcnt vmcnt(0)
    v_perm_b32 v199, v60, v56, s14
    v_perm_b32 v207, v60, v56, s15
    v_perm_b32 v215, v61, v57, s14
    v_perm_b32 v223, v61, v57, s15
    v_perm_b32 v231, v62, v58, s14
    v_perm_b32 v239, v62, v58, s15
    v_perm_b32 v247, v63, v59, s14
    v_perm_b32 v255, v63, v59, s15
    s_mov_b32 s9, 163840
    buffer_load_dwordx4 v[32:35], v7, s[44:47], s9 offen offset:0
    buffer_load_dwordx4 v[36:39], v7, s[44:47], s9 offen offset:1280
    buffer_load_dwordx4 v[40:43], v7, s[44:47], s9 offen offset:2560
    buffer_load_dwordx4 v[44:47], v7, s[44:47], s9 offen offset:3840
    s_waitcnt vmcnt(0)
    s_mov_b32 s9, 168960
    buffer_load_dwordx4 v[48:51], v7, s[44:47], s9 offen offset:0
    buffer_load_dwordx4 v[52:55], v7, s[44:47], s9 offen offset:1280
    buffer_load_dwordx4 v[56:59], v7, s[44:47], s9 offen offset:2560
    buffer_load_dwordx4 v[60:63], v7, s[44:47], s9 offen offset:3840
    s_waitcnt vmcnt(6)
    v_perm_b32 v192, v36, v32, s14
    v_perm_b32 v200, v36, v32, s15
    v_perm_b32 v208, v37, v33, s14
    v_perm_b32 v216, v37, v33, s15
    v_perm_b32 v224, v38, v34, s14
    v_perm_b32 v232, v38, v34, s15
    v_perm_b32 v240, v39, v35, s14
    v_perm_b32 v248, v39, v35, s15
    s_waitcnt vmcnt(4)
    v_perm_b32 v193, v44, v40, s14
    v_perm_b32 v201, v44, v40, s15
    v_perm_b32 v209, v45, v41, s14
    v_perm_b32 v217, v45, v41, s15
    v_perm_b32 v225, v46, v42, s14
    v_perm_b32 v233, v46, v42, s15
    v_perm_b32 v241, v47, v43, s14
    v_perm_b32 v249, v47, v43, s15
    s_waitcnt vmcnt(2)
    v_perm_b32 v194, v52, v48, s14
    v_perm_b32 v202, v52, v48, s15
    v_perm_b32 v210, v53, v49, s14
    v_perm_b32 v218, v53, v49, s15
    v_perm_b32 v226, v54, v50, s14
    v_perm_b32 v234, v54, v50, s15
    v_perm_b32 v242, v55, v51, s14
    v_perm_b32 v250, v55, v51, s15
    s_waitcnt vmcnt(0)
    v_perm_b32 v195, v60, v56, s14
    v_perm_b32 v203, v60, v56, s15
    v_perm_b32 v211, v61, v57, s14
    v_perm_b32 v219, v61, v57, s15
    v_perm_b32 v227, v62, v58, s14
    v_perm_b32 v235, v62, v58, s15
    v_perm_b32 v243, v63, v59, s14
    v_perm_b32 v251, v63, v59, s15
    s_cmp_lg_u32 s3, 2
    s_cbranch_scc1 L_nodn
    s_sub_u32 s52, s52, 64
    s_cmp_ge_u32 s52, 120
    s_cbranch_scc1 L_nodn
    s_mul_hi_u32 s53, s52, 429496730
    s_mul_i32 s54, s53, 10
    s_sub_u32 s54, s52, s54
    s_mov_b32 s60, s34
    s_mov_b32 s61, s35
    s_mov_b32 s62, 1966080
    s_mov_b32 s63, 0x20000
    v_lshrrev_b32 v4, 3, v0
    v_mul_u32_u24 v5, 20480, v4
    v_and_b32 v6, 7, v0
    v_lshl_add_u32 v5, v6, 4, v5
    s_mul_i32 s9, s53, 163840
    s_lshl_b32 s10, s54, 7
    s_add_u32 s9, s9, s10
    buffer_load_dwordx4 v[64:67], v5, s[60:63], s9 offen offset:0 nt
    buffer_load_dwordx4 v[68:71], v5, s[60:63], s9 offen offset:1280 nt
    buffer_load_dwordx4 v[72:75], v5, s[60:63], s9 offen offset:2560 nt
    buffer_load_dwordx4 v[76:79], v5, s[60:63], s9 offen offset:3840 nt
    s_add_u32 s9, s9, 5120
    buffer_load_dwordx4 v[80:83], v5, s[60:63], s9 offen offset:0 nt
    buffer_load_dwordx4 v[84:87], v5, s[60:63], s9 offen offset:1280 nt
    buffer_load_dwordx4 v[88:91], v5, s[60:63], s9 offen offset:2560 nt
    buffer_load_dwordx4 v[92:95], v5, s[60:63], s9 offen offset:3840 nt
    s_add_u32 s9, s9, 5120
    s_waitcnt vmcnt(0)
    buffer_load_dwordx4 v[96:99], v5, s[60:63], s9 offen offset:0 nt
    buffer_load_dwordx4 v[100:103], v5, s[60:63], s9 offen offset:1280 nt
    buffer_load_dwordx4 v[104:107], v5, s[60:63], s9 offen offset:2560 nt
    buffer_load_dwordx4 v[108:111], v5, s[60:63], s9 offen offset:3840 nt
    s_add_u32 s9, s9, 5120
    buffer_load_dwordx4 v[112:115], v5, s[60:63], s9 offen offset:0 nt
    buffer_load_dwordx4 v[116:119], v5, s[60:63], s9 offen offset:1280 nt
    buffer_load_dwordx4 v[120:123], v5, s[60:63], s9 offen offset:2560 nt
    buffer_load_dwordx4 v[124:127], v5, s[60:63], s9 offen offset:3840 nt
    s_add_u32 s9, s9, 5120
    v_lshrrev_b32 v60, 5, v0
    v_lshlrev_b32 v61, 12, v60
    v_and_b32 v62, 31, v0
    v_lshl_add_u32 v61, v62, 4, v61
    s_lshl_b32 s9, s53, 13
    s_add_u32 s9, s9, 930048
    s_mov_b64 s[80:81], -1
    s_mov_b64 s[82:83], -1
    s_mov_b64 s[84:85], -1
    s_mov_b64 s[86:87], -1
    s_mov_b64 s[88:89], -1
    s_mov_b64 s[90:91], -1
    s_mov_b64 s[92:93], -1
    s_mov_b64 s[94:95], -1
    s_mov_b32 s12, 262144
mp_37:
    s_mov_b64 exec, s[80:81]
    s_cbranch_execz ml_39
    buffer_load_dwordx4 v[128:131], v61, s[56:59], s9 offen offset:0 sc1
ml_39:
    s_mov_b64 exec, s[82:83]
    s_cbranch_execz ml_40
    buffer_load_dwordx4 v[132:135], v61, s[56:59], s9 offen offset:512 sc1
ml_40:
    s_mov_b64 exec, s[84:85]
    s_cbranch_execz ml_41
    buffer_load_dwordx4 v[136:139], v61, s[56:59], s9 offen offset:1024 sc1
ml_41:
    s_mov_b64 exec, s[86:87]
    s_cbranch_execz ml_42
    buffer_load_dwordx4 v[140:143], v61, s[56:59], s9 offen offset:1536 sc1
ml_42:
    s_mov_b64 exec, s[88:89]
    s_cbranch_execz ml_43
    buffer_load_dwordx4 v[144:147], v61, s[56:59], s9 offen offset:2048 sc1
ml_43:
    s_mov_b64 exec, s[90:91]
    s_cbranch_execz ml_44
    buffer_load_dwordx4 v[148:151], v61, s[56:59], s9 offen offset:2560 sc1
ml_44:
    s_mov_b64 exec, s[92:93]
    s_cbranch_execz ml_45
    buffer_load_dwordx4 v[152:155], v61, s[56:59], s9 offen offset:3072 sc1
ml_45:
    s_mov_b64 exec, s[94:95]
    s_cbranch_execz ml_46
    buffer_load_dwordx4 v[156:159], v61, s[56:59], s9 offen offset:3584 sc1
ml_46:
    s_mov_b64 s[100:101], 0
    s_waitcnt vmcnt(0)
    s_mov_b64 exec, s[80:81]
    s_cbranch_execz mc_47
    v_xor_b32 v128, s96, v128
    v_xor_b32 v129, s97, v129
    v_xor_b32 v130, s98, v130
    v_xor_b32 v131, s99, v131
    v_or_b32 v27, v128, v129
    v_or3_b32 v27, v130, v131, v27
    v_and_b32 v27, 15, v27
    v_cmp_ne_u32 vcc, 0, v27
    s_cmp_lg_u64 vcc, 0
    s_cselect_b64 s[80:81], s[80:81], 0
    s_or_b64 s[100:101], s[100:101], s[80:81]
mc_47:
    s_mov_b64 exec, s[82:83]
    s_cbranch_execz mc_48
    v_xor_b32 v132, s96, v132
    v_xor_b32 v133, s97, v133
    v_xor_b32 v134, s98, v134
    v_xor_b32 v135, s99, v135
    v_or_b32 v27, v132, v133
    v_or3_b32 v27, v134, v135, v27
    v_and_b32 v27, 15, v27
    v_cmp_ne_u32 vcc, 0, v27
    s_cmp_lg_u64 vcc, 0
    s_cselect_b64 s[82:83], s[82:83], 0
    s_or_b64 s[100:101], s[100:101], s[82:83]
mc_48:
    s_mov_b64 exec, s[84:85]
    s_cbranch_execz mc_49
    v_xor_b32 v136, s96, v136
    v_xor_b32 v137, s97, v137
    v_xor_b32 v138, s98, v138
    v_xor_b32 v139, s99, v139
    v_or_b32 v27, v136, v137
    v_or3_b32 v27, v138, v139, v27
    v_and_b32 v27, 15, v27
    v_cmp_ne_u32 vcc, 0, v27
    s_cmp_lg_u64 vcc, 0
    s_cselect_b64 s[84:85], s[84:85], 0
    s_or_b64 s[100:101], s[100:101], s[84:85]
mc_49:
    s_mov_b64 exec, s[86:87]
    s_cbranch_execz mc_50
    v_xor_b32 v140, s96, v140
    v_xor_b32 v141, s97, v141
    v_xor_b32 v142, s98, v142
    v_xor_b32 v143, s99, v143
    v_or_b32 v27, v140, v141
    v_or3_b32 v27, v142, v143, v27
    v_and_b32 v27, 15, v27
    v_cmp_ne_u32 vcc, 0, v27
    s_cmp_lg_u64 vcc, 0
    s_cselect_b64 s[86:87], s[86:87], 0
    s_or_b64 s[100:101], s[100:101], s[86:87]
mc_50:
    s_mov_b64 exec, s[88:89]
    s_cbranch_execz mc_51
    v_xor_b32 v144, s96, v144
    v_xor_b32 v145, s97, v145
    v_xor_b32 v146, s98, v146
    v_xor_b32 v147, s99, v147
    v_or_b32 v27, v144, v145
    v_or3_b32 v27, v146, v147, v27
    v_and_b32 v27, 15, v27
    v_cmp_ne_u32 vcc, 0, v27
    s_cmp_lg_u64 vcc, 0
    s_cselect_b64 s[88:89], s[88:89], 0
    s_or_b64 s[100:101], s[100:101], s[88:89]
mc_51:
    s_mov_b64 exec, s[90:91]
    s_cbranch_execz mc_52
    v_xor_b32 v148, s96, v148
    v_xor_b32 v149, s97, v149
    v_xor_b32 v150, s98, v150
    v_xor_b32 v151, s99, v151
    v_or_b32 v27, v148, v149
    v_or3_b32 v27, v150, v151, v27
    v_and_b32 v27, 15, v27
    v_cmp_ne_u32 vcc, 0, v27
    s_cmp_lg_u64 vcc, 0
    s_cselect_b64 s[90:91], s[90:91], 0
    s_or_b64 s[100:101], s[100:101], s[90:91]
mc_52:
    s_mov_b64 exec, s[92:93]
    s_cbranch_execz mc_53
    v_xor_b32 v152, s96, v152
    v_xor_b32 v153, s97, v153
    v_xor_b32 v154, s98, v154
    v_xor_b32 v155, s99, v155
    v_or_b32 v27, v152, v153
    v_or3_b32 v27, v154, v155, v27
    v_and_b32 v27, 15, v27
    v_cmp_ne_u32 vcc, 0, v27
    s_cmp_lg_u64 vcc, 0
    s_cselect_b64 s[92:93], s[92:93], 0
    s_or_b64 s[100:101], s[100:101], s[92:93]
mc_53:
    s_mov_b64 exec, s[94:95]
    s_cbranch_execz mc_54
    v_xor_b32 v156, s96, v156
    v_xor_b32 v157, s97, v157
    v_xor_b32 v158, s98, v158
    v_xor_b32 v159, s99, v159
    v_or_b32 v27, v156, v157
    v_or3_b32 v27, v158, v159, v27
    v_and_b32 v27, 15, v27
    v_cmp_ne_u32 vcc, 0, v27
    s_cmp_lg_u64 vcc, 0
    s_cselect_b64 s[94:95], s[94:95], 0
    s_or_b64 s[100:101], s[100:101], s[94:95]
mc_54:
    s_mov_b64 exec, -1
    s_cmp_eq_u64 s[100:101], 0
    s_cbranch_scc1 mpd_38
    s_sleep 32
    s_sub_u32 s12, s12, 1
    s_cmp_gt_u32 s12, 0
    s_cbranch_scc1 mp_37
mpd_38:
    v_pk_add_f32 v[128:129], v[128:129], v[132:133]
    v_pk_add_f32 v[130:131], v[130:131], v[134:135]
    v_pk_add_f32 v[128:129], v[128:129], v[136:137]
    v_pk_add_f32 v[130:131], v[130:131], v[138:139]
    v_pk_add_f32 v[128:129], v[128:129], v[140:141]
    v_pk_add_f32 v[130:131], v[130:131], v[142:143]
    v_pk_add_f32 v[144:145], v[144:145], v[148:149]
    v_pk_add_f32 v[146:147], v[146:147], v[150:151]
    v_pk_add_f32 v[144:145], v[144:145], v[152:153]
    v_pk_add_f32 v[146:147], v[146:147], v[154:155]
    v_pk_add_f32 v[144:145], v[144:145], v[156:157]
    v_pk_add_f32 v[146:147], v[146:147], v[158:159]
    v_cvt_pk_bf16_f32 v128, v128, v128
    v_lshlrev_b32 v128, 16, v128
    v_cvt_pk_bf16_f32 v144, v144, v144
    v_lshlrev_b32 v144, 16, v144
    v_mul_f32 v132, 0xbfb8aa3b, v128
    v_exp_f32 v132, v132
    s_nop 0
    v_add_f32 v132, 1.0, v132
    v_rcp_f32 v132, v132
    s_nop 0
    v_mul_f32 v128, v128, v132
    v_cvt_pk_bf16_f32 v128, v128, v128
    v_lshlrev_b32 v128, 16, v128
    v_mul_f32 v128, v128, v144
    v_cvt_pk_bf16_f32 v129, v129, v129
    v_lshlrev_b32 v129, 16, v129
    v_cvt_pk_bf16_f32 v145, v145, v145
    v_lshlrev_b32 v145, 16, v145
    v_mul_f32 v132, 0xbfb8aa3b, v129
    v_exp_f32 v132, v132
    s_nop 0
    v_add_f32 v132, 1.0, v132
    v_rcp_f32 v132, v132
    s_nop 0
    v_mul_f32 v129, v129, v132
    v_cvt_pk_bf16_f32 v129, v129, v129
    v_lshlrev_b32 v129, 16, v129
    v_mul_f32 v129, v129, v145
    v_cvt_pk_bf16_f32 v130, v130, v130
    v_lshlrev_b32 v130, 16, v130
    v_cvt_pk_bf16_f32 v146, v146, v146
    v_lshlrev_b32 v146, 16, v146
    v_mul_f32 v132, 0xbfb8aa3b, v130
    v_exp_f32 v132, v132
    s_nop 0
    v_add_f32 v132, 1.0, v132
    v_rcp_f32 v132, v132
    s_nop 0
    v_mul_f32 v130, v130, v132
    v_cvt_pk_bf16_f32 v130, v130, v130
    v_lshlrev_b32 v130, 16, v130
    v_mul_f32 v130, v130, v146
    v_cvt_pk_bf16_f32 v131, v131, v131
    v_lshlrev_b32 v131, 16, v131
    v_cvt_pk_bf16_f32 v147, v147, v147
    v_lshlrev_b32 v147, 16, v147
    v_mul_f32 v132, 0xbfb8aa3b, v131
    v_exp_f32 v132, v132
    s_nop 0
    v_add_f32 v132, 1.0, v132
    v_rcp_f32 v132, v132
    s_nop 0
    v_mul_f32 v131, v131, v132
    v_cvt_pk_bf16_f32 v131, v131, v131
    v_lshlrev_b32 v131, 16, v131
    v_mul_f32 v131, v131, v147
    v_cvt_pk_bf16_f32 v132, v128, v129
    v_cvt_pk_bf16_f32 v133, v130, v131
    v_bfe_u32 v61, v0, 4, 1
    v_lshlrev_b32 v62, 8, v61
    v_lshl_add_u32 v62, v60, 7, v62
    v_and_b32 v63, 15, v0
    v_lshl_add_u32 v62, v63, 3, v62
    ds_write_b64 v62, v[132:133] offset:11072
    v_lshlrev_b32 v4, 5, v4
    v_mul_u32_u24 v5, 2560, v60
    v_lshl_add_u32 v5, v6, 5, v5
    v_lshl_add_u32 v5, v61, 4, v5
    s_mul_i32 s9, s53, 5120
    s_lshl_b32 s10, s54, 8
    s_add_u32 s9, s9, s10
    s_add_u32 s9, s9, 672000
    s_waitcnt lgkmcnt(0)
    ds_read_b128 v[44:47], v4 offset:11072
    ds_read_b128 v[48:51], v4 offset:11088
    ds_read_b128 v[52:55], v4 offset:11328
    ds_read_b128 v[56:59], v4 offset:11344
    s_waitcnt lgkmcnt(0)
    v_perm_b32 v28, v44, v44, v18
    v_perm_b32 v29, v44, v44, v19
    v_perm_b32 v30, v44, v44, v20
    v_perm_b32 v31, v44, v44, v21
    v_perm_b32 v32, v52, v52, v18
    v_perm_b32 v33, v52, v52, v19
    v_perm_b32 v34, v52, v52, v20
    v_perm_b32 v35, v52, v52, v21
    s_nop 1
    v_mfma_f32_16x16x32_bf16 v[36:39], v[28:31], v[64:67], 0
    v_mfma_f32_16x16x32_bf16 v[40:43], v[32:35], v[64:67], 0
    v_perm_b32 v28, v44, v44, v22
    v_perm_b32 v29, v44, v44, v23
    v_perm_b32 v30, v44, v44, v24
    v_perm_b32 v31, v44, v44, v25
    v_perm_b32 v32, v52, v52, v22
    v_perm_b32 v33, v52, v52, v23
    v_perm_b32 v34, v52, v52, v24
    v_perm_b32 v35, v52, v52, v25
    s_nop 1
    v_mfma_f32_16x16x32_bf16 v[36:39], v[28:31], v[68:71], v[36:39]
    v_mfma_f32_16x16x32_bf16 v[40:43], v[32:35], v[68:71], v[40:43]
    v_perm_b32 v28, v45, v45, v18
    v_perm_b32 v29, v45, v45, v19
    v_perm_b32 v30, v45, v45, v20
    v_perm_b32 v31, v45, v45, v21
    v_perm_b32 v32, v53, v53, v18
    v_perm_b32 v33, v53, v53, v19
    v_perm_b32 v34, v53, v53, v20
    v_perm_b32 v35, v53, v53, v21
    s_nop 1
    v_mfma_f32_16x16x32_bf16 v[36:39], v[28:31], v[72:75], v[36:39]
    v_mfma_f32_16x16x32_bf16 v[40:43], v[32:35], v[72:75], v[40:43]
    v_perm_b32 v28, v45, v45, v22
    v_perm_b32 v29, v45, v45, v23
    v_perm_b32 v30, v45, v45, v24
    v_perm_b32 v31, v45, v45, v25
    v_perm_b32 v32, v53, v53, v22
    v_perm_b32 v33, v53, v53, v23
    v_perm_b32 v34, v53, v53, v24
    v_perm_b32 v35, v53, v53, v25
    s_nop 1
    v_mfma_f32_16x16x32_bf16 v[36:39], v[28:31], v[76:79], v[36:39]
    v_mfma_f32_16x16x32_bf16 v[40:43], v[32:35], v[76:79], v[40:43]
    v_perm_b32 v28, v46, v46, v18
    v_perm_b32 v29, v46, v46, v19
    v_perm_b32 v30, v46, v46, v20
    v_perm_b32 v31, v46, v46, v21
    v_perm_b32 v32, v54, v54, v18
    v_perm_b32 v33, v54, v54, v19
    v_perm_b32 v34, v54, v54, v20
    v_perm_b32 v35, v54, v54, v21
    s_nop 1
    v_mfma_f32_16x16x32_bf16 v[36:39], v[28:31], v[80:83], v[36:39]
    v_mfma_f32_16x16x32_bf16 v[40:43], v[32:35], v[80:83], v[40:43]
    v_perm_b32 v28, v46, v46, v22
    v_perm_b32 v29, v46, v46, v23
    v_perm_b32 v30, v46, v46, v24
    v_perm_b32 v31, v46, v46, v25
    v_perm_b32 v32, v54, v54, v22
    v_perm_b32 v33, v54, v54, v23
    v_perm_b32 v34, v54, v54, v24
    v_perm_b32 v35, v54, v54, v25
    s_nop 1
    v_mfma_f32_16x16x32_bf16 v[36:39], v[28:31], v[84:87], v[36:39]
    v_mfma_f32_16x16x32_bf16 v[40:43], v[32:35], v[84:87], v[40:43]
    v_perm_b32 v28, v47, v47, v18
    v_perm_b32 v29, v47, v47, v19
    v_perm_b32 v30, v47, v47, v20
    v_perm_b32 v31, v47, v47, v21
    v_perm_b32 v32, v55, v55, v18
    v_perm_b32 v33, v55, v55, v19
    v_perm_b32 v34, v55, v55, v20
    v_perm_b32 v35, v55, v55, v21
    s_nop 1
    v_mfma_f32_16x16x32_bf16 v[36:39], v[28:31], v[88:91], v[36:39]
    v_mfma_f32_16x16x32_bf16 v[40:43], v[32:35], v[88:91], v[40:43]
    v_perm_b32 v28, v47, v47, v22
    v_perm_b32 v29, v47, v47, v23
    v_perm_b32 v30, v47, v47, v24
    v_perm_b32 v31, v47, v47, v25
    v_perm_b32 v32, v55, v55, v22
    v_perm_b32 v33, v55, v55, v23
    v_perm_b32 v34, v55, v55, v24
    v_perm_b32 v35, v55, v55, v25
    s_nop 1
    v_mfma_f32_16x16x32_bf16 v[36:39], v[28:31], v[92:95], v[36:39]
    v_mfma_f32_16x16x32_bf16 v[40:43], v[32:35], v[92:95], v[40:43]
    v_perm_b32 v28, v48, v48, v18
    v_perm_b32 v29, v48, v48, v19
    v_perm_b32 v30, v48, v48, v20
    v_perm_b32 v31, v48, v48, v21
    v_perm_b32 v32, v56, v56, v18
    v_perm_b32 v33, v56, v56, v19
    v_perm_b32 v34, v56, v56, v20
    v_perm_b32 v35, v56, v56, v21
    s_nop 1
    v_mfma_f32_16x16x32_bf16 v[36:39], v[28:31], v[96:99], v[36:39]
    v_mfma_f32_16x16x32_bf16 v[40:43], v[32:35], v[96:99], v[40:43]
    v_perm_b32 v28, v48, v48, v22
    v_perm_b32 v29, v48, v48, v23
    v_perm_b32 v30, v48, v48, v24
    v_perm_b32 v31, v48, v48, v25
    v_perm_b32 v32, v56, v56, v22
    v_perm_b32 v33, v56, v56, v23
    v_perm_b32 v34, v56, v56, v24
    v_perm_b32 v35, v56, v56, v25
    s_nop 1
    v_mfma_f32_16x16x32_bf16 v[36:39], v[28:31], v[100:103], v[36:39]
    v_mfma_f32_16x16x32_bf16 v[40:43], v[32:35], v[100:103], v[40:43]
    v_perm_b32 v28, v49, v49, v18
    v_perm_b32 v29, v49, v49, v19
    v_perm_b32 v30, v49, v49, v20
    v_perm_b32 v31, v49, v49, v21
    v_perm_b32 v32, v57, v57, v18
    v_perm_b32 v33, v57, v57, v19
    v_perm_b32 v34, v57, v57, v20
    v_perm_b32 v35, v57, v57, v21
    s_nop 1
    v_mfma_f32_16x16x32_bf16 v[36:39], v[28:31], v[104:107], v[36:39]
    v_mfma_f32_16x16x32_bf16 v[40:43], v[32:35], v[104:107], v[40:43]
    v_perm_b32 v28, v49, v49, v22
    v_perm_b32 v29, v49, v49, v23
    v_perm_b32 v30, v49, v49, v24
    v_perm_b32 v31, v49, v49, v25
    v_perm_b32 v32, v57, v57, v22
    v_perm_b32 v33, v57, v57, v23
    v_perm_b32 v34, v57, v57, v24
    v_perm_b32 v35, v57, v57, v25
    s_nop 1
    v_mfma_f32_16x16x32_bf16 v[36:39], v[28:31], v[108:111], v[36:39]
    v_mfma_f32_16x16x32_bf16 v[40:43], v[32:35], v[108:111], v[40:43]
    v_perm_b32 v28, v50, v50, v18
    v_perm_b32 v29, v50, v50, v19
    v_perm_b32 v30, v50, v50, v20
    v_perm_b32 v31, v50, v50, v21
    v_perm_b32 v32, v58, v58, v18
    v_perm_b32 v33, v58, v58, v19
    v_perm_b32 v34, v58, v58, v20
    v_perm_b32 v35, v58, v58, v21
    s_nop 1
    v_mfma_f32_16x16x32_bf16 v[36:39], v[28:31], v[112:115], v[36:39]
    v_mfma_f32_16x16x32_bf16 v[40:43], v[32:35], v[112:115], v[40:43]
    v_perm_b32 v28, v50, v50, v22
    v_perm_b32 v29, v50, v50, v23
    v_perm_b32 v30, v50, v50, v24
    v_perm_b32 v31, v50, v50, v25
    v_perm_b32 v32, v58, v58, v22
    v_perm_b32 v33, v58, v58, v23
    v_perm_b32 v34, v58, v58, v24
    v_perm_b32 v35, v58, v58, v25
    s_nop 1
    v_mfma_f32_16x16x32_bf16 v[36:39], v[28:31], v[116:119], v[36:39]
    v_mfma_f32_16x16x32_bf16 v[40:43], v[32:35], v[116:119], v[40:43]
    v_perm_b32 v28, v51, v51, v18
    v_perm_b32 v29, v51, v51, v19
    v_perm_b32 v30, v51, v51, v20
    v_perm_b32 v31, v51, v51, v21
    v_perm_b32 v32, v59, v59, v18
    v_perm_b32 v33, v59, v59, v19
    v_perm_b32 v34, v59, v59, v20
    v_perm_b32 v35, v59, v59, v21
    s_nop 1
    v_mfma_f32_16x16x32_bf16 v[36:39], v[28:31], v[120:123], v[36:39]
    v_mfma_f32_16x16x32_bf16 v[40:43], v[32:35], v[120:123], v[40:43]
    v_perm_b32 v28, v51, v51, v22
    v_perm_b32 v29, v51, v51, v23
    v_perm_b32 v30, v51, v51, v24
    v_perm_b32 v31, v51, v51, v25
    v_perm_b32 v32, v59, v59, v22
    v_perm_b32 v33, v59, v59, v23
    v_perm_b32 v34, v59, v59, v24
    v_perm_b32 v35, v59, v59, v25
    s_nop 1
    v_mfma_f32_16x16x32_bf16 v[36:39], v[28:31], v[124:127], v[36:39]
    v_mfma_f32_16x16x32_bf16 v[40:43], v[32:35], v[124:127], v[40:43]
    s_nop 7
    v_permlane32_swap_b32 v36, v40
    v_permlane32_swap_b32 v37, v41
    v_permlane32_swap_b32 v38, v42
    v_permlane32_swap_b32 v39, v43
    s_nop 1
    v_add_f32_dpp v36, v40, v36 row_ror:8 row_mask:0xf bank_mask:0xf
    v_add_f32_dpp v37, v41, v37 row_ror:8 row_mask:0xf bank_mask:0xf
    v_add_f32_dpp v38, v42, v38 row_ror:8 row_mask:0xf bank_mask:0xf
    v_add_f32_dpp v39, v43, v39 row_ror:8 row_mask:0xf bank_mask:0xf
    v_add_u32 v36, 8, v36
    v_bfi_b32 v36, v26, s96, v36
    v_add_u32 v37, 8, v37
    v_bfi_b32 v37, v26, s97, v37
    v_add_u32 v38, 8, v38
    v_bfi_b32 v38, v26, s98, v38
    v_add_u32 v39, 8, v39
    v_bfi_b32 v39, v26, s99, v39
    s_mov_b32 exec_lo, 0x00ff00ff
    s_mov_b32 exec_hi, 0x00ff00ff
    buffer_store_dwordx4 v[36:39], v5, s[56:59], s9 offen sc1
    s_mov_b64 exec, -1
    s_waitcnt vmcnt(0)
L_nodn:
    s_mov_b32 s9, 122880
    buffer_load_dwordx4 v[32:35], v7, s[44:47], s9 offen offset:0
    buffer_load_dwordx4 v[36:39], v7, s[44:47], s9 offen offset:1280
    buffer_load_dwordx4 v[40:43], v7, s[44:47], s9 offen offset:2560
    buffer_load_dwordx4 v[44:47], v7, s[44:47], s9 offen offset:3840
    s_waitcnt vmcnt(0)
    s_mov_b32 s9, 128000
    buffer_load_dwordx4 v[48:51], v7, s[44:47], s9 offen offset:0
    buffer_load_dwordx4 v[52:55], v7, s[44:47], s9 offen offset:1280
    buffer_load_dwordx4 v[56:59], v7, s[44:47], s9 offen offset:2560
    buffer_load_dwordx4 v[60:63], v7, s[44:47], s9 offen offset:3840
    s_waitcnt vmcnt(6)
    v_perm_b32 v132, v36, v32, s14
    v_perm_b32 v140, v36, v32, s15
    v_perm_b32 v148, v37, v33, s14
    v_perm_b32 v156, v37, v33, s15
    v_perm_b32 v164, v38, v34, s14
    v_perm_b32 v172, v38, v34, s15
    v_perm_b32 v180, v39, v35, s14
    v_perm_b32 v188, v39, v35, s15
    s_waitcnt vmcnt(4)
    v_perm_b32 v133, v44, v40, s14
    v_perm_b32 v141, v44, v40, s15
    v_perm_b32 v149, v45, v41, s14
    v_perm_b32 v157, v45, v41, s15
    v_perm_b32 v165, v46, v42, s14
    v_perm_b32 v173, v46, v42, s15
    v_perm_b32 v181, v47, v43, s14
    v_perm_b32 v189, v47, v43, s15
    s_waitcnt vmcnt(2)
    v_perm_b32 v134, v52, v48, s14
    v_perm_b32 v142, v52, v48, s15
    v_perm_b32 v150, v53, v49, s14
    v_perm_b32 v158, v53, v49, s15
    v_perm_b32 v166, v54, v50, s14
    v_perm_b32 v174, v54, v50, s15
    v_perm_b32 v182, v55, v51, s14
    v_perm_b32 v190, v55, v51, s15
    s_waitcnt vmcnt(0)
    v_perm_b32 v135, v60, v56, s14
    v_perm_b32 v143, v60, v56, s15
    v_perm_b32 v151, v61, v57, s14
    v_perm_b32 v159, v61, v57, s15
    v_perm_b32 v167, v62, v58, s14
    v_perm_b32 v175, v62, v58, s15
    v_perm_b32 v183, v63, v59, s14
    v_perm_b32 v191, v63, v59, s15
    s_mov_b32 s9, 81920
    buffer_load_dwordx4 v[32:35], v7, s[44:47], s9 offen offset:0
    buffer_load_dwordx4 v[36:39], v7, s[44:47], s9 offen offset:1280
    buffer_load_dwordx4 v[40:43], v7, s[44:47], s9 offen offset:2560
    buffer_load_dwordx4 v[44:47], v7, s[44:47], s9 offen offset:3840
    s_waitcnt vmcnt(0)
    s_mov_b32 s9, 87040
    buffer_load_dwordx4 v[48:51], v7, s[44:47], s9 offen offset:0
    buffer_load_dwordx4 v[52:55], v7, s[44:47], s9 offen offset:1280
    buffer_load_dwordx4 v[56:59], v7, s[44:47], s9 offen offset:2560
    buffer_load_dwordx4 v[60:63], v7, s[44:47], s9 offen offset:3840
    s_waitcnt vmcnt(6)
    v_perm_b32 v128, v36, v32, s14
    v_perm_b32 v136, v36, v32, s15
    v_perm_b32 v144, v37, v33, s14
    v_perm_b32 v152, v37, v33, s15
    v_perm_b32 v160, v38, v34, s14
    v_perm_b32 v168, v38, v34, s15
    v_perm_b32 v176, v39, v35, s14
    v_perm_b32 v184, v39, v35, s15
    s_waitcnt vmcnt(4)
    v_perm_b32 v129, v44, v40, s14
    v_perm_b32 v137, v44, v40, s15
    v_perm_b32 v145, v45, v41, s14
    v_perm_b32 v153, v45, v41, s15
    v_perm_b32 v161, v46, v42, s14
    v_perm_b32 v169, v46, v42, s15
    v_perm_b32 v177, v47, v43, s14
    v_perm_b32 v185, v47, v43, s15
    s_waitcnt vmcnt(2)
    v_perm_b32 v130, v52, v48, s14
    v_perm_b32 v138, v52, v48, s15
    v_perm_b32 v146, v53, v49, s14
    v_perm_b32 v154, v53, v49, s15
    v_perm_b32 v162, v54, v50, s14
    v_perm_b32 v170, v54, v50, s15
    v_perm_b32 v178, v55, v51, s14
    v_perm_b32 v186, v55, v51, s15
    s_waitcnt vmcnt(0)
    v_perm_b32 v131, v60, v56, s14
    v_perm_b32 v139, v60, v56, s15
    v_perm_b32 v147, v61, v57, s14
    v_perm_b32 v155, v61, v57, s15
    v_perm_b32 v163, v62, v58, s14
    v_perm_b32 v171, v62, v58, s15
    v_perm_b32 v179, v63, v59, s14
    v_perm_b32 v187, v63, v59, s15
    s_mov_b32 s9, 40960
    buffer_load_dwordx4 v[32:35], v7, s[44:47], s9 offen offset:0
    buffer_load_dwordx4 v[36:39], v7, s[44:47], s9 offen offset:1280
    buffer_load_dwordx4 v[40:43], v7, s[44:47], s9 offen offset:2560
    buffer_load_dwordx4 v[44:47], v7, s[44:47], s9 offen offset:3840
    s_waitcnt vmcnt(0)
    s_mov_b32 s9, 46080
    buffer_load_dwordx4 v[48:51], v7, s[44:47], s9 offen offset:0
    buffer_load_dwordx4 v[52:55], v7, s[44:47], s9 offen offset:1280
    buffer_load_dwordx4 v[56:59], v7, s[44:47], s9 offen offset:2560
    buffer_load_dwordx4 v[60:63], v7, s[44:47], s9 offen offset:3840
    s_waitcnt vmcnt(6)
    v_perm_b32 v68, v36, v32, s14
    v_perm_b32 v76, v36, v32, s15
    v_perm_b32 v84, v37, v33, s14
    v_perm_b32 v92, v37, v33, s15
    v_perm_b32 v100, v38, v34, s14
    v_perm_b32 v108, v38, v34, s15
    v_perm_b32 v116, v39, v35, s14
    v_perm_b32 v124, v39, v35, s15
    s_waitcnt vmcnt(4)
    v_perm_b32 v69, v44, v40, s14
    v_perm_b32 v77, v44, v40, s15
    v_perm_b32 v85, v45, v41, s14
    v_perm_b32 v93, v45, v41, s15
    v_perm_b32 v101, v46, v42, s14
    v_perm_b32 v109, v46, v42, s15
    v_perm_b32 v117, v47, v43, s14
    v_perm_b32 v125, v47, v43, s15
    s_waitcnt vmcnt(2)
    v_perm_b32 v70, v52, v48, s14
    v_perm_b32 v78, v52, v48, s15
    v_perm_b32 v86, v53, v49, s14
    v_perm_b32 v94, v53, v49, s15
    v_perm_b32 v102, v54, v50, s14
    v_perm_b32 v110, v54, v50, s15
    v_perm_b32 v118, v55, v51, s14
    v_perm_b32 v126, v55, v51, s15
    s_waitcnt vmcnt(0)
    v_perm_b32 v71, v60, v56, s14
    v_perm_b32 v79, v60, v56, s15
    v_perm_b32 v87, v61, v57, s14
    v_perm_b32 v95, v61, v57, s15
    v_perm_b32 v103, v62, v58, s14
    v_perm_b32 v111, v62, v58, s15
    v_perm_b32 v119, v63, v59, s14
    v_perm_b32 v127, v63, v59, s15
    s_mov_b32 s9, 0
    buffer_load_dwordx4 v[32:35], v7, s[44:47], s9 offen offset:0
    buffer_load_dwordx4 v[36:39], v7, s[44:47], s9 offen offset:1280
    buffer_load_dwordx4 v[40:43], v7, s[44:47], s9 offen offset:2560
    buffer_load_dwordx4 v[44:47], v7, s[44:47], s9 offen offset:3840
    s_waitcnt vmcnt(0)
    s_mov_b32 s9, 5120
    buffer_load_dwordx4 v[48:51], v7, s[44:47], s9 offen offset:0
    buffer_load_dwordx4 v[52:55], v7, s[44:47], s9 offen offset:1280
    buffer_load_dwordx4 v[56:59], v7, s[44:47], s9 offen offset:2560
    buffer_load_dwordx4 v[60:63], v7, s[44:47], s9 offen offset:3840
    s_waitcnt vmcnt(6)
    v_perm_b32 v64, v36, v32, s14
    v_perm_b32 v72, v36, v32, s15
    v_perm_b32 v80, v37, v33, s14
    v_perm_b32 v88, v37, v33, s15
    v_perm_b32 v96, v38, v34, s14
    v_perm_b32 v104, v38, v34, s15
    v_perm_b32 v112, v39, v35, s14
    v_perm_b32 v120, v39, v35, s15
    s_waitcnt vmcnt(4)
    v_perm_b32 v65, v44, v40, s14
    v_perm_b32 v73, v44, v40, s15
    v_perm_b32 v81, v45, v41, s14
    v_perm_b32 v89, v45, v41, s15
    v_perm_b32 v97, v46, v42, s14
    v_perm_b32 v105, v46, v42, s15
    v_perm_b32 v113, v47, v43, s14
    v_perm_b32 v121, v47, v43, s15
    s_waitcnt vmcnt(2)
    v_perm_b32 v66, v52, v48, s14
    v_perm_b32 v74, v52, v48, s15
    v_perm_b32 v82, v53, v49, s14
    v_perm_b32 v90, v53, v49, s15
    v_perm_b32 v98, v54, v50, s14
    v_perm_b32 v106, v54, v50, s15
    v_perm_b32 v114, v55, v51, s14
    v_perm_b32 v122, v55, v51, s15
    s_waitcnt vmcnt(0)
    v_perm_b32 v67, v60, v56, s14
    v_perm_b32 v75, v60, v56, s15
    v_perm_b32 v83, v61, v57, s14
    v_perm_b32 v91, v61, v57, s15
    v_perm_b32 v99, v62, v58, s14
    v_perm_b32 v107, v62, v58, s15
    v_perm_b32 v115, v63, v59, s14
    v_perm_b32 v123, v63, v59, s15
    s_cmp_lg_u32 s3, 0
    s_cbranch_scc1 L_noep
    s_cmp_lg_u32 s2, 0
    s_cbranch_scc1 L_noep
    s_mov_b32 s12, 262144
    v_lshlrev_b32 v40, 6, v0
    v_mov_b32 v41, s78
    s_mov_b32 s9, 655368
    s_mov_b32 s10, 659464
    s_mov_b32 s11, 663560
    s_mov_b32 s13, 667656
c0_55:
    s_sleep 127
    buffer_load_dword v32, v40, s[56:59], s9 offen sc1
    buffer_load_dword v33, v40, s[56:59], s10 offen sc1
    buffer_load_dword v34, v40, s[56:59], s11 offen sc1
    buffer_load_dword v35, v40, s[56:59], s13 offen sc1
    s_waitcnt vmcnt(0)
    v_xor_b32 v32, v32, v41
    v_xor_b32 v33, v33, v41
    v_xor_b32 v34, v34, v41
    v_xor_b32 v35, v35, v41
    v_or_b32 v27, v32, v33
    v_or3_b32 v27, v34, v35, v27
    v_cmp_ne_u32 vcc, 0, v27
    s_cbranch_vccz c0d_56
    s_sub_u32 s12, s12, 1
    s_cmp_gt_u32 s12, 0
    s_cbranch_scc1 c0_55
c0d_56:
    v_mov_b32 v32, 0
    s_mov_b32 s9, 671744
    s_mov_b64 exec, 1
    buffer_store_dword v41, v32, s[56:59], s9 offen sc1
    s_mov_b64 exec, -1
L_noep:
    s_cmp_lg_u32 s3, 3
    s_cbranch_scc1 L_nostat
    v_mov_b32 v48, 0
    v_lshlrev_b32 v36, 4, v0
    s_mov_b32 s12, 4194304
    s_mov_b64 exec, 15
cw_57:
    ds_read_b128 v[32:35], v36 offset:11584
    s_waitcnt lgkmcnt(0)
    v_cmp_ne_u32 vcc, s78, v34
    s_cbranch_vccz cwd_58
    s_sleep 8
    s_sub_u32 s12, s12, 1
    s_cmp_gt_u32 s12, 0
    s_cbranch_scc1 cw_57
cwd_58:
    s_lshl_b32 s9, s7, 6
    s_add_u32 s9, s9, 655360
    buffer_store_dwordx4 v[32:35], v36, s[56:59], s9 offen sc1
    s_mov_b64 exec, -1
    s_sleep 64
    v_lshlrev_b32 v36, 3, v3
    v_and_b32 v37, 1, v3
    v_lshl_add_u32 v36, v37, 2, v36
    v_add_u32 v36, s4, v36
    v_and_b32 v36, 31, v36
    v_lshlrev_b32 v36, 8, v36
    v_lshl_add_u32 v36, v2, 4, v36
    s_lshl_b32 s9, s5, 13
    s_add_u32 s9, s9, 655360
    v_mov_b32 v37, s78
    s_mov_b32 s12, 262144
st_59:
    buffer_load_dwordx4 v[32:35], v36, s[56:59], s9 offen sc1
    s_memrealtime s[10:11]
    s_waitcnt vmcnt(0) lgkmcnt(0)
    v_xor_b32 v32, s96, v32
    v_xor_b32 v33, s97, v33
    v_or_b32 v27, v32, v33
    v_and_b32 v27, 15, v27
    v_bitop3_b32 v27, v34, v37, v27 bitop3:0xbe
    v_cmp_ne_u32 vcc, 0, v27
    s_and_b32 s13, vcc_lo, 0xffff
    s_cbranch_scc0 std_60
    s_sleep 16
    s_sub_u32 s12, s12, 1
    s_cmp_gt_u32 s12, 0
    s_cbranch_scc1 st_59
std_60:
    s_mov_b64 exec, -1
    v_sub_u32 v38, s10, v35
    v_cvt_f32_i32 v38, v38
    v_cndmask_b32 v38, v38, 0, vcc
    s_lshl_b32 s9, s6, 2
    v_subrev_u32 v39, s9, v0
    v_cmp_gt_u32 vcc, 4, v39
    v_mul_f32 v39, 0xc1700000, v38
    s_nop 0
    v_cndmask_b32 v38, v38, v39, vcc
    s_nop 1
    v_add_f32_dpp v38, v38, v38 row_ror:1 row_mask:0xf bank_mask:0xf
    s_nop 1
    v_add_f32_dpp v38, v38, v38 row_ror:2 row_mask:0xf bank_mask:0xf
    s_nop 1
    v_add_f32_dpp v38, v38, v38 row_ror:4 row_mask:0xf bank_mask:0xf
    s_nop 1
    v_add_f32_dpp v38, v38, v38 row_ror:8 row_mask:0xf bank_mask:0xf
    v_mov_b32 v39, v38
    s_nop 1
    v_permlane16_swap_b32 v38, v39
    s_nop 1
    v_add_f32 v38, v38, v39
    v_mov_b32 v39, v38
    s_nop 1
    v_permlane32_swap_b32 v38, v39
    s_nop 1
    v_add_f32 v38, v38, v39
    v_mul_f32 v38, 0x3c800000, v38
    v_add_f32 v39, 0x41f00000, v38
    v_mul_f32 v39, 0x00000000, v39
    v_min_f32 v39, 0, v39
    v_subrev_f32 v38, 0x41f00000, v38
    v_mul_f32 v38, 0x3dcccccd, v38
    v_max_f32 v38, 0, v38
    v_add_f32 v38, v38, v39
    v_min_f32 v38, 64.0, v38
    v_max_f32 v38, 0xc1c00000, v38
    v_cvt_i32_f32 v38, v38
    v_and_b32 v38, 0xffff, v38
    v_or_b32 v38, 65536, v38
    ds_write_b32 v48, v38 offset:11060
    v_mov_b32 v34, v32
    s_nop 1
    v_max_f32_dpp v34, v34, v34 row_ror:1 row_mask:0xf bank_mask:0xf
    s_nop 1
    v_max_f32_dpp v34, v34, v34 row_ror:2 row_mask:0xf bank_mask:0xf
    s_nop 1
    v_max_f32_dpp v34, v34, v34 row_ror:4 row_mask:0xf bank_mask:0xf
    s_nop 1
    v_max_f32_dpp v34, v34, v34 row_ror:8 row_mask:0xf bank_mask:0xf
    v_sub_f32 v32, v32, v34
    v_mul_f32 v32, 1069066811, v32
    v_exp_f32 v32, v32
    s_nop 0
    v_mul_f32 v33, v33, v32
    s_nop 1
    v_add_f32_dpp v33, v33, v33 row_ror:1 row_mask:0xf bank_mask:0xf
    s_nop 1
    v_add_f32_dpp v33, v33, v33 row_ror:2 row_mask:0xf bank_mask:0xf
    s_nop 1
    v_add_f32_dpp v33, v33, v33 row_ror:4 row_mask:0xf bank_mask:0xf
    s_nop 1
    v_add_f32_dpp v33, v33, v33 row_ror:8 row_mask:0xf bank_mask:0xf
    v_rcp_f32 v34, v33
    s_nop 0
    v_mul_f32 v35, v32, v34
    v_fma_f32 v32, -v35, v33, v32
    v_fmac_f32 v35, v32, v34
    s_lshl_b32 s9, s6, 2
    v_subrev_u32 v36, s9, v0
    v_cmp_gt_u32 vcc, 4, v36
    v_lshlrev_b32 v36, 2, v36
    s_and_saveexec_b64 s[10:11], vcc
    ds_write_b32 v36, v35 offset:11008
    s_mov_b64 exec, -1
    v_bfe_u32 v36, v0, 2, 2
    v_and_b32 v38, 1, v36
    v_lshlrev_b32 v36, 3, v36
    v_lshl_add_u32 v36, v38, 2, v36
    v_add_u32 v36, s4, v36
    v_and_b32 v36, 31, v36
    v_lshlrev_b32 v36, 9, v36
    v_and_b32 v38, 3, v0
    v_lshl_add_u32 v36, v38, 7, v36
    v_mov_b32 v41, s78
    s_mov_b32 s12, 4194304
cw_61:
    ds_read_b32 v32, v48 offset:11056
    s_waitcnt lgkmcnt(0)
    v_readfirstlane_b32 s9, v32
    s_cmp_ge_u32 s9, 4
    s_cbranch_scc1 cwd_62
    s_sleep 2
    s_sub_u32 s12, s12, 1
    s_cmp_gt_u32 s12, 0
    s_cbranch_scc1 cw_61
cwd_62:
    ds_read_b32 v40, v48 offset:62224
    s_lshl_b32 s9, s8, 9
    s_lshl_b32 s13, s6, 7
    s_add_u32 s9, s9, s13
    s_add_u32 s9, s9, 1061120
    s_waitcnt lgkmcnt(0)
    v_readfirstlane_b32 s10, v40
    s_mov_b64 exec, 1
    buffer_store_dwordx2 v[40:41], v48, s[56:59], s9 offen sc1
    s_mov_b32 exec_lo, 0xffff
    s_mov_b32 exec_hi, 0
    s_sleep 48
    s_lshl_b32 s9, s5, 11
    s_lshl_b32 s9, s9, 3
    s_add_u32 s9, s9, 1061120
    buffer_load_dwordx2 v[32:33], v36, s[56:59], s9 offen sc1
    s_memrealtime s[12:13]
    s_waitcnt vmcnt(0) lgkmcnt(0)
    v_cmp_ne_u32 vcc, v33, v41
    v_sub_u32 v38, s12, v32
    v_cvt_f32_i32 v38, v38
    v_cndmask_b32 v38, v38, 0, vcc
    s_sub_u32 s12, s12, s10
    v_cvt_f32_u32 v39, s12
    s_nop 1
    v_add_f32_dpp v38, v38, v38 row_ror:1 row_mask:0xf bank_mask:0xf
    s_nop 1
    v_add_f32_dpp v38, v38, v38 row_ror:2 row_mask:0xf bank_mask:0xf
    s_nop 1
    v_add_f32_dpp v38, v38, v38 row_ror:4 row_mask:0xf bank_mask:0xf
    s_nop 1
    v_add_f32_dpp v38, v38, v38 row_ror:8 row_mask:0xf bank_mask:0xf
    v_mul_f32 v38, 0x3d800000, v38
    v_sub_f32 v38, v38, v39
    v_add_f32 v39, 0x41f00000, v38
    v_mul_f32 v39, 0x00000000, v39
    v_min_f32 v39, 0, v39
    v_subrev_f32 v38, 0x41f00000, v38
    v_mul_f32 v38, 0x3db851ec, v38
    v_max_f32 v38, 0, v38
    v_add_f32 v38, v38, v39
    v_min_f32 v38, 64.0, v38
    v_max_f32 v38, 0xc1c00000, v38
    v_cvt_i32_f32 v38, v38
    v_and_b32 v38, 0xffff, v38
    v_or_b32 v38, 131072, v38
    ds_write_b32 v48, v38 offset:11060
    s_mov_b64 exec, -1
    s_mov_b32 s12, 4194304
cw_63:
    ds_read_b32 v32, v48 offset:11056
    s_waitcnt lgkmcnt(0)
    v_readfirstlane_b32 s9, v32
    s_cmp_ge_u32 s9, 7
    s_cbranch_scc1 cwd_64
    s_sleep 2
    s_sub_u32 s12, s12, 1
    s_cmp_gt_u32 s12, 0
    s_cbranch_scc1 cw_63
cwd_64:
    ds_read_b32 v40, v48 offset:62236
    s_lshl_b32 s9, s8, 9
    s_lshl_b32 s13, s6, 7
    s_add_u32 s9, s9, s13
    s_add_u32 s9, s9, 1093888
    s_waitcnt lgkmcnt(0)
    v_readfirstlane_b32 s10, v40
    s_mov_b64 exec, 1
    buffer_store_dwordx2 v[40:41], v48, s[56:59], s9 offen sc1
    s_mov_b32 exec_lo, 0xffff
    s_mov_b32 exec_hi, 0
    s_sleep 32
    s_lshl_b32 s9, s5, 11
    s_lshl_b32 s9, s9, 3
    s_add_u32 s9, s9, 1093888
    buffer_load_dwordx2 v[32:33], v36, s[56:59], s9 offen sc1
    s_memrealtime s[12:13]
    s_waitcnt vmcnt(0) lgkmcnt(0)
    v_cmp_ne_u32 vcc, v33, v41
    v_sub_u32 v38, s12, v32
    v_cvt_f32_i32 v38, v38
    v_cndmask_b32 v38, v38, 0, vcc
    s_sub_u32 s12, s12, s10
    v_cvt_f32_u32 v39, s12
    s_nop 1
    v_add_f32_dpp v38, v38, v38 row_ror:1 row_mask:0xf bank_mask:0xf
    s_nop 1
    v_add_f32_dpp v38, v38, v38 row_ror:2 row_mask:0xf bank_mask:0xf
    s_nop 1
    v_add_f32_dpp v38, v38, v38 row_ror:4 row_mask:0xf bank_mask:0xf
    s_nop 1
    v_add_f32_dpp v38, v38, v38 row_ror:8 row_mask:0xf bank_mask:0xf
    v_mul_f32 v38, 0x3d800000, v38
    v_sub_f32 v38, v38, v39
    v_add_f32 v39, 0x41f00000, v38
    v_mul_f32 v39, 0x00000000, v39
    v_min_f32 v39, 0, v39
    v_subrev_f32 v38, 0x41f00000, v38
    v_mul_f32 v38, 0x3da3d70a, v38
    v_max_f32 v38, 0, v38
    v_add_f32 v38, v38, v39
    v_min_f32 v38, 64.0, v38
    v_max_f32 v38, 0xc1c00000, v38
    v_cvt_i32_f32 v38, v38
    v_and_b32 v38, 0xffff, v38
    v_or_b32 v38, 196608, v38
    ds_write_b32 v48, v38 offset:11060
    s_mov_b64 exec, -1
L_nostat:
    s_lshl_b32 s67, s6, 5
    s_add_u32 s67, s67, s4
    s_mov_b32 s68, 0
    s_cmp_lg_u32 s3, 2
    s_cbranch_scc1 L_noown
    s_cmp_ge_u32 s67, 40
    s_cbranch_scc1 L_noown
    s_mov_b32 s68, 1
    s_mov_b32 s60, s28
    s_mov_b32 s61, s29
    s_mov_b32 s62, 1280
    s_mov_b32 s63, 0x20000
    v_lshlrev_b32 v52, 2, v0
    s_mul_i32 s9, s5, 1280
    v_add_u32 v53, s9, v52
    buffer_load_dword v32, v52, s[60:63], 0 offen offset:0
    ds_read_b32 v37, v53 offset:0
    buffer_load_dword v33, v52, s[60:63], 0 offen offset:256
    ds_read_b32 v38, v53 offset:256
    buffer_load_dword v34, v52, s[60:63], 0 offen offset:512
    ds_read_b32 v39, v53 offset:512
    buffer_load_dword v35, v52, s[60:63], 0 offen offset:768
    ds_read_b32 v40, v53 offset:768
    buffer_load_dword v36, v52, s[60:63], 0 offen offset:1024
    ds_read_b32 v41, v53 offset:1024
    s_mov_b32 s60, s16
    s_mov_b32 s61, s17
    s_mov_b32 s62, 2560
    s_mov_b32 s63, 0x20000
    v_and_b32 v54, 3, v0
    v_lshl_add_u32 v10, v54, 2, v3
    v_lshlrev_b32 v10, 1, v10
    s_lshl_b32 s10, s67, 5
    s_add_u32 s10, s10, s9
    v_add_u32 v10, s10, v10
    buffer_load_ushort v9, v10, s[60:63], 0 offen
    ds_read_u16 v55, v10 offset:0
    s_waitcnt vmcnt(0) lgkmcnt(0)
    v_dot2_f32_bf16 v56, v32, v37, 0
    v_dot2_f32_bf16 v56, v33, v38, v56
    v_dot2_f32_bf16 v56, v34, v39, v56
    v_dot2_f32_bf16 v56, v35, v40, v56
    v_dot2_f32_bf16 v56, v36, v41, v56
    v_lshlrev_b32 v9, 16, v9
    v_lshlrev_b32 v55, 16, v55
    s_nop 1
    s_nop 1
    v_add_f32_dpp v56, v56, v56 row_ror:1 row_mask:0xf bank_mask:0xf
    s_nop 1
    v_add_f32_dpp v56, v56, v56 row_ror:2 row_mask:0xf bank_mask:0xf
    s_nop 1
    v_add_f32_dpp v56, v56, v56 row_ror:4 row_mask:0xf bank_mask:0xf
    s_nop 1
    v_add_f32_dpp v56, v56, v56 row_ror:8 row_mask:0xf bank_mask:0xf
    v_mov_b32 v57, v56
    s_nop 1
    v_permlane16_swap_b32 v56, v57
    s_nop 1
    v_add_f32 v56, v56, v57
    v_mov_b32 v57, v56
    s_nop 1
    v_permlane32_swap_b32 v56, v57
    s_nop 1
    v_add_f32 v56, v56, v57
    v_cvt_pk_bf16_f32 v56, v56, v56
    v_lshlrev_b32 v56, 16, v56
    v_mul_f32 v56, 0xbfb8aa3b, v56
    v_exp_f32 v56, v56
    s_nop 0
    v_add_f32 v56, 1.0, v56
    v_rcp_f32 v56, v56
    s_nop 0
    v_cvt_pk_bf16_f32 v56, v56, v56
    v_lshlrev_b32 v56, 16, v56
    v_lshrrev_b32 v52, 2, v0
    v_mul_u32_u24 v53, 5120, v52
    v_lshl_add_u32 v53, v54, 4, v53
    v_mul_u32_u24 v11, 2560, v52
    v_lshl_add_u32 v11, v54, 4, v11
    s_mul_i32 s9, s5, 2560
    s_lshl_b32 s10, s67, 6
    s_add_u32 s9, s9, s10
    s_add_u32 s9, s9, 672000
    v_mov_b32 v32, 0
    v_mov_b32 v33, 0
    v_mov_b32 v34, 0
    v_mov_b32 v35, 0
    s_mov_b32 s80, -1
    s_mov_b32 s81, 0xffff
    s_mov_b32 s12, 262144
mp_67:
    s_mov_b64 exec, s[80:81]
    s_cbranch_execz ml_69
    buffer_load_dwordx4 v[32:35], v53, s[56:59], s9 offen sc1
ml_69:
    s_mov_b64 s[100:101], 0
    s_waitcnt vmcnt(0)
    s_mov_b64 exec, s[80:81]
    s_cbranch_execz mc_70
    v_xor_b32 v32, s96, v32
    v_xor_b32 v33, s97, v33
    v_xor_b32 v34, s98, v34
    v_xor_b32 v35, s99, v35
    v_or_b32 v27, v32, v33
    v_or3_b32 v27, v34, v35, v27
    v_and_b32 v27, 15, v27
    v_cmp_ne_u32 vcc, 0, v27
    s_cmp_lg_u64 vcc, 0
    s_cselect_b64 s[80:81], s[80:81], 0
    s_or_b64 s[100:101], s[100:101], s[80:81]
mc_70:
    s_mov_b64 exec, -1
    s_cmp_eq_u64 s[100:101], 0
    s_cbranch_scc1 mpd_68
    s_sleep 64
    s_sub_u32 s12, s12, 1
    s_cmp_gt_u32 s12, 0
    s_cbranch_scc1 mp_67
mpd_68:
    s_nop 1
    v_permlane16_swap_b32 v32, v33
    v_permlane16_swap_b32 v34, v35
    s_nop 1
    v_add_f32 v32, v32, v33
    v_add_f32 v34, v34, v35
    s_nop 1
    v_permlane32_swap_b32 v32, v34
    s_nop 1
    v_add_f32 v32, v32, v34
    s_nop 1
    v_add_f32_dpp v32, v32, v32 row_ror:4 row_mask:0xf bank_mask:0xf
    s_nop 1
    v_add_f32_dpp v32, v32, v32 row_ror:8 row_mask:0xf bank_mask:0xf
    v_cvt_pk_bf16_f32 v32, v32, v32
    v_lshlrev_b32 v32, 16, v32
    v_mul_f32 v32, v32, v56
    v_cvt_pk_bf16_f32 v32, v32, v32
    v_lshlrev_b32 v32, 16, v32
    v_add_f32 v32, v32, v55
    v_cvt_pk_bf16_f32 v32, v32, v32
    v_lshlrev_b32 v32, 16, v32
    v_mul_f32 v33, 0xbfb8aa3b, v32
    v_exp_f32 v33, v33
    s_nop 0
    v_add_f32 v33, 1.0, v33
    v_rcp_f32 v33, v33
    s_nop 0
    v_mul_f32 v8, v32, v33
    v_cvt_pk_bf16_f32 v8, v8, v8
    v_lshlrev_b32 v8, 16, v8
    s_mul_i32 s70, s5, 327680
    s_lshl_b32 s10, s67, 6
    s_add_u32 s70, s70, s10
    s_add_u32 s71, s70, 40960
    s_add_u32 s72, s70, 81920
    s_add_u32 s73, s70, 122880
    s_add_u32 s74, s70, 163840
    s_add_u32 s75, s70, 204800
    s_add_u32 s76, s70, 245760
    s_add_u32 s77, s70, 286720
L_noown:
    s_mov_b32 s60, s36
    s_mov_b32 s61, s37
    s_mov_b32 s62, 2560
    s_mov_b32 s63, 0x20000
    v_and_b32 v14, 7, v0
    v_mul_u32_u24 v14, 416, v14
    v_lshl_add_u32 v14, v3, 4, v14
    v_bfe_u32 v4, v0, 3, 1
    v_mul_u32_u24 v5, 192, v4
    v_add_u32 v14, v14, v5
    v_mul_u32_u24 v24, 0xaaaa, v4
    v_add_u32 v24, 0x4444, v24
    v_lshl_or_b32 v24, v24, 16, v24
    v_and_b32 v4, 1, v3
    v_lshlrev_b32 v15, 5, v2
    v_lshl_add_u32 v15, v4, 4, v15
    v_lshrrev_b32 v5, 5, v0
    v_lshl_add_u32 v15, v5, 3, v15
    v_lshlrev_b32 v4, 3, v4
    s_mul_i32 s9, s7, 2560
    s_lshl_b32 s10, s3, 9
    s_add_u32 s9, s9, s10
    s_waitcnt vmcnt(0) lgkmcnt(0)
    s_setprio 3
    s_mov_b32 s43, 1
    s_mov_b64 s[80:81], -1
    s_mov_b64 s[82:83], -1
    s_mov_b64 s[84:85], -1
    s_mov_b64 s[86:87], -1
    s_mov_b64 s[88:89], -1
    s_mov_b64 s[90:91], -1
    s_mov_b64 s[92:93], -1
    s_mov_b64 s[94:95], -1
    s_mov_b32 s79, 0xfffff000
    s_mul_i32 s10, s78, 0x9e3779b1
    s_and_b32 s96, s78, 0xfff
    s_bfe_u32 s97, s10, 0xc0008
    s_lshr_b32 s98, s10, 20
    s_mul_i32 s10, s78, 0x85ebca6b
    s_lshr_b32 s99, s10, 20
    v_mov_b32 v25, 0xfff
    v_mov_b32 v26, s96
    v_mov_b32 v7, s97
    s_mov_b32 exec_lo, 0
    v_mov_b32 v26, s98
    v_mov_b32 v7, s99
    s_mov_b32 exec_lo, -1
L_tail:
    v_mov_b32 v32, 0
    v_mov_b32 v33, 0
    v_mov_b32 v34, 0
    v_mov_b32 v35, 0
    v_mov_b32 v36, 0
    v_mov_b32 v37, 0
    v_mov_b32 v38, 0
    v_mov_b32 v39, 0
    v_mov_b32 v40, 0
    v_mov_b32 v41, 0
    v_mov_b32 v42, 0
    v_mov_b32 v43, 0
    v_mov_b32 v44, 0
    v_mov_b32 v45, 0
    v_mov_b32 v46, 0
    v_mov_b32 v47, 0
    v_mov_b32 v48, 0
    v_mov_b32 v49, 0
    v_mov_b32 v50, 0
    v_mov_b32 v51, 0
    v_mov_b32 v52, 0
    v_mov_b32 v53, 0
    v_mov_b32 v54, 0
    v_mov_b32 v55, 0
    v_mov_b32 v56, 0
    v_mov_b32 v57, 0
    v_mov_b32 v58, 0
    v_mov_b32 v59, 0
    v_mov_b32 v60, 0
    v_mov_b32 v61, 0
    v_mov_b32 v62, 0
    v_mov_b32 v63, 0
    s_cmp_lg_u32 s43, 0
    s_cbranch_scc1 L_nobar
    s_barrier
L_nobar:
    ds_read_b128 v[16:19], v14 offset:7680
    ds_read_b128 v[20:23], v14 offset:7744
    ds_read_b128 v[28:31], v14 offset:7808
    ds_read_b64 v[12:13], v4 offset:11008
    s_waitcnt lgkmcnt(3)
    v_smfmac_f32_16x16x64_bf16 v[32:35], v[16:19], v[64:71], v24
    v_smfmac_f32_16x16x64_bf16 v[48:51], v[16:19], v[96:103], v24
    s_waitcnt lgkmcnt(2)
    v_smfmac_f32_16x16x64_bf16 v[32:35], v[20:23], v[128:135], v24
    v_smfmac_f32_16x16x64_bf16 v[48:51], v[20:23], v[160:167], v24
    s_waitcnt lgkmcnt(1)
    v_smfmac_f32_16x16x64_bf16 v[32:35], v[28:31], v[192:199], v24
    v_smfmac_f32_16x16x64_bf16 v[48:51], v[28:31], v[224:231], v24
    v_smfmac_f32_16x16x64_bf16 v[40:43], v[16:19], v[80:87], v24
    v_smfmac_f32_16x16x64_bf16 v[56:59], v[16:19], v[112:119], v24
    v_smfmac_f32_16x16x64_bf16 v[40:43], v[20:23], v[144:151], v24
    v_smfmac_f32_16x16x64_bf16 v[56:59], v[20:23], v[176:183], v24
    v_smfmac_f32_16x16x64_bf16 v[40:43], v[28:31], v[208:215], v24
    v_smfmac_f32_16x16x64_bf16 v[56:59], v[28:31], v[240:247], v24
    s_waitcnt lgkmcnt(0)
    v_smfmac_f32_16x16x64_bf16 v[36:39], v[16:19], v[72:79], v24
    v_smfmac_f32_16x16x64_bf16 v[52:55], v[16:19], v[104:111], v24
    v_smfmac_f32_16x16x64_bf16 v[36:39], v[20:23], v[136:143], v24
    v_add_f32 v32, v32, v33
    v_add_f32 v34, v34, v35
    v_smfmac_f32_16x16x64_bf16 v[52:55], v[20:23], v[168:175], v24
    v_add_f32 v48, v48, v49
    v_add_f32 v50, v50, v51
    v_smfmac_f32_16x16x64_bf16 v[36:39], v[28:31], v[200:207], v24
    v_mul_f32 v32, v32, v12
    v_fmac_f32 v32, v34, v13
    v_smfmac_f32_16x16x64_bf16 v[52:55], v[28:31], v[232:239], v24
    v_mul_f32 v48, v48, v12
    v_fmac_f32 v48, v50, v13
    v_smfmac_f32_16x16x64_bf16 v[44:47], v[16:19], v[88:95], v24
    v_add_f32 v40, v40, v41
    v_add_f32 v42, v42, v43
    v_smfmac_f32_16x16x64_bf16 v[60:63], v[16:19], v[120:127], v24
    v_add_f32 v56, v56, v57
    v_add_f32 v58, v58, v59
    v_smfmac_f32_16x16x64_bf16 v[44:47], v[20:23], v[152:159], v24
    v_mul_f32 v40, v40, v12
    v_fmac_f32 v40, v42, v13
    v_smfmac_f32_16x16x64_bf16 v[60:63], v[20:23], v[184:191], v24
    v_mul_f32 v56, v56, v12
    v_fmac_f32 v56, v58, v13
    v_smfmac_f32_16x16x64_bf16 v[44:47], v[28:31], v[216:223], v24
    v_permlane16_swap_b32 v32, v48
    s_nop 0
    v_smfmac_f32_16x16x64_bf16 v[60:63], v[28:31], v[248:255], v24
    v_add_f32 v32, v32, v48
    v_permlane16_swap_b32 v40, v56
    v_add_f32 v40, v40, v56
    v_add_f32 v36, v36, v37
    v_add_f32 v38, v38, v39
    v_add_f32 v52, v52, v53
    v_add_f32 v54, v54, v55
    v_mul_f32 v36, v36, v12
    v_fmac_f32 v36, v38, v13
    v_mul_f32 v52, v52, v12
    v_fmac_f32 v52, v54, v13
    v_permlane32_swap_b32 v32, v40
    v_add_f32 v44, v44, v45
    v_add_f32 v46, v46, v47
    v_add_f32 v60, v60, v61
    v_add_f32 v62, v62, v63
    v_permlane16_swap_b32 v36, v52
    v_add_f32 v16, v32, v40
    v_mul_f32 v44, v44, v12
    v_fmac_f32 v44, v46, v13
    v_mul_f32 v60, v60, v12
    v_fmac_f32 v60, v62, v13
    v_add_f32 v36, v36, v52
    v_add_u32 v16, 2048, v16
    v_and_or_b32 v16, v16, s79, v26
    v_permlane16_swap_b32 v44, v60
    s_nop 0
    v_add_f32 v44, v44, v60
    s_nop 1
    v_permlane32_swap_b32 v36, v44
    s_nop 0
    v_add_f32 v17, v36, v44
    v_add_u32 v17, 2048, v17
    v_and_or_b32 v17, v17, s79, v7
    v_permlane32_swap_b32 v16, v18
    s_nop 0
    v_permlane32_swap_b32 v17, v19
    s_cmp_lg_u32 s43, 0
    s_cbranch_scc1 L_nost
    s_mov_b32 exec_hi, 0
    buffer_store_dwordx4 v[16:19], v15, s[56:59], s9 offen sc1
    s_mov_b32 exec_hi, -1
    s_cmp_eq_u32 s68, 0
    s_cbranch_scc1 L_end
    s_mov_b32 s12, 262144
L_pp:
    s_mov_b64 exec, s[80:81]
    s_cbranch_execz pl_71
    buffer_load_dwordx4 v[64:67], v11, s[56:59], s70 offen sc1
pl_71:
    s_mov_b64 exec, s[82:83]
    s_cbranch_execz pl_72
    buffer_load_dwordx4 v[68:71], v11, s[56:59], s71 offen sc1
pl_72:
    s_mov_b64 exec, s[84:85]
    s_cbranch_execz pl_73
    buffer_load_dwordx4 v[72:75], v11, s[56:59], s72 offen sc1
pl_73:
    s_mov_b64 exec, s[86:87]
    s_cbranch_execz pl_74
    buffer_load_dwordx4 v[76:79], v11, s[56:59], s73 offen sc1
pl_74:
    s_mov_b64 exec, s[88:89]
    s_cbranch_execz pl_75
    buffer_load_dwordx4 v[80:83], v11, s[56:59], s74 offen sc1
pl_75:
    s_mov_b64 exec, s[90:91]
    s_cbranch_execz pl_76
    buffer_load_dwordx4 v[84:87], v11, s[56:59], s75 offen sc1
pl_76:
    s_mov_b64 exec, s[92:93]
    s_cbranch_execz pl_77
    buffer_load_dwordx4 v[88:91], v11, s[56:59], s76 offen sc1
pl_77:
    s_mov_b64 exec, s[94:95]
    s_cbranch_execz pl_78
    buffer_load_dwordx4 v[92:95], v11, s[56:59], s77 offen sc1
pl_78:
    s_mov_b32 s13, 0
    s_waitcnt vmcnt(0)
    s_mov_b64 exec, s[80:81]
    s_cbranch_execz pc_79
    v_xor_b32 v32, s96, v64
    v_xor_b32 v33, s97, v65
    v_xor_b32 v34, s98, v66
    v_xor_b32 v35, s99, v67
    v_or3_b32 v27, v32, v33, v34
    v_bitop3_b32 v27, v27, v35, v25 bitop3:0xa8
    v_cmp_ne_u32 s[80:81], 0, v27
    s_bcnt1_i32_b64 s10, s[80:81]
    s_add_u32 s13, s13, s10
pc_79:
    s_mov_b64 exec, s[82:83]
    s_cbranch_execz pc_80
    v_xor_b32 v36, s96, v68
    v_xor_b32 v37, s97, v69
    v_xor_b32 v38, s98, v70
    v_xor_b32 v39, s99, v71
    v_or3_b32 v27, v36, v37, v38
    v_bitop3_b32 v27, v27, v39, v25 bitop3:0xa8
    v_cmp_ne_u32 s[82:83], 0, v27
    s_bcnt1_i32_b64 s10, s[82:83]
    s_add_u32 s13, s13, s10
pc_80:
    s_mov_b64 exec, s[84:85]
    s_cbranch_execz pc_81
    v_xor_b32 v40, s96, v72
    v_xor_b32 v41, s97, v73
    v_xor_b32 v42, s98, v74
    v_xor_b32 v43, s99, v75
    v_or3_b32 v27, v40, v41, v42
    v_bitop3_b32 v27, v27, v43, v25 bitop3:0xa8
    v_cmp_ne_u32 s[84:85], 0, v27
    s_bcnt1_i32_b64 s10, s[84:85]
    s_add_u32 s13, s13, s10
pc_81:
    s_mov_b64 exec, s[86:87]
    s_cbranch_execz pc_82
    v_xor_b32 v44, s96, v76
    v_xor_b32 v45, s97, v77
    v_xor_b32 v46, s98, v78
    v_xor_b32 v47, s99, v79
    v_or3_b32 v27, v44, v45, v46
    v_bitop3_b32 v27, v27, v47, v25 bitop3:0xa8
    v_cmp_ne_u32 s[86:87], 0, v27
    s_bcnt1_i32_b64 s10, s[86:87]
    s_add_u32 s13, s13, s10
pc_82:
    s_mov_b64 exec, s[88:89]
    s_cbranch_execz pc_83
    v_xor_b32 v48, s96, v80
    v_xor_b32 v49, s97, v81
    v_xor_b32 v50, s98, v82
    v_xor_b32 v51, s99, v83
    v_or3_b32 v27, v48, v49, v50
    v_bitop3_b32 v27, v27, v51, v25 bitop3:0xa8
    v_cmp_ne_u32 s[88:89], 0, v27
    s_bcnt1_i32_b64 s10, s[88:89]
    s_add_u32 s13, s13, s10
pc_83:
    s_mov_b64 exec, s[90:91]
    s_cbranch_execz pc_84
    v_xor_b32 v52, s96, v84
    v_xor_b32 v53, s97, v85
    v_xor_b32 v54, s98, v86
    v_xor_b32 v55, s99, v87
    v_or3_b32 v27, v52, v53, v54
    v_bitop3_b32 v27, v27, v55, v25 bitop3:0xa8
    v_cmp_ne_u32 s[90:91], 0, v27
    s_bcnt1_i32_b64 s10, s[90:91]
    s_add_u32 s13, s13, s10
pc_84:
    s_mov_b64 exec, s[92:93]
    s_cbranch_execz pc_85
    v_xor_b32 v56, s96, v88
    v_xor_b32 v57, s97, v89
    v_xor_b32 v58, s98, v90
    v_xor_b32 v59, s99, v91
    v_or3_b32 v27, v56, v57, v58
    v_bitop3_b32 v27, v27, v59, v25 bitop3:0xa8
    v_cmp_ne_u32 s[92:93], 0, v27
    s_bcnt1_i32_b64 s10, s[92:93]
    s_add_u32 s13, s13, s10
pc_85:
    s_mov_b64 exec, s[94:95]
    s_cbranch_execz pc_86
    v_xor_b32 v60, s96, v92
    v_xor_b32 v61, s97, v93
    v_xor_b32 v62, s98, v94
    v_xor_b32 v63, s99, v95
    v_or3_b32 v27, v60, v61, v62
    v_bitop3_b32 v27, v27, v63, v25 bitop3:0xa8
    v_cmp_ne_u32 s[94:95], 0, v27
    s_bcnt1_i32_b64 s10, s[94:95]
    s_add_u32 s13, s13, s10
pc_86:
    s_mov_b64 exec, -1
    s_cmp_eq_u32 s13, 0
    s_cbranch_scc1 L_nost
    s_cmp_le_u32 s13, 32
    s_cbranch_scc1 L_pn
    s_sleep 8
L_pn:
    s_sub_u32 s12, s12, 1
    s_cmp_gt_u32 s12, 0
    s_cbranch_scc1 L_pp
L_nost:
    v_pk_add_f32 v[32:33], v[32:33], v[36:37]
    v_pk_add_f32 v[34:35], v[34:35], v[38:39]
    v_pk_add_f32 v[40:41], v[40:41], v[44:45]
    v_pk_add_f32 v[42:43], v[42:43], v[46:47]
    v_pk_add_f32 v[48:49], v[48:49], v[52:53]
    v_pk_add_f32 v[50:51], v[50:51], v[54:55]
    v_pk_add_f32 v[56:57], v[56:57], v[60:61]
    v_pk_add_f32 v[58:59], v[58:59], v[62:63]
    v_pk_add_f32 v[32:33], v[32:33], v[40:41]
    v_pk_add_f32 v[34:35], v[34:35], v[42:43]
    v_pk_add_f32 v[48:49], v[48:49], v[56:57]
    v_pk_add_f32 v[50:51], v[50:51], v[58:59]
    v_pk_add_f32 v[32:33], v[32:33], v[48:49]
    v_pk_add_f32 v[34:35], v[34:35], v[50:51]
    s_nop 1
    v_permlane16_swap_b32 v32, v33
    v_permlane16_swap_b32 v34, v35
    s_nop 1
    v_add_f32 v32, v32, v33
    v_add_f32 v34, v34, v35
    s_nop 1
    v_permlane32_swap_b32 v32, v34
    s_nop 1
    v_add_f32 v32, v32, v34
    s_nop 1
    v_add_f32_dpp v32, v32, v32 row_ror:4 row_mask:0xf bank_mask:0xf
    s_nop 1
    v_add_f32_dpp v32, v32, v32 row_ror:8 row_mask:0xf bank_mask:0xf
    v_cvt_pk_bf16_f32 v32, v32, v32
    v_lshlrev_b32 v32, 16, v32
    v_mul_f32 v32, v32, v8
    v_cvt_pk_bf16_f32 v32, v32, v32
    v_lshlrev_b32 v32, 16, v32
    v_add_f32 v32, v32, v9
    v_cvt_pk_bf16_f32 v32, v32, v32
    s_cmp_eq_u32 s43, 0
    s_cbranch_scc1 L_fin
    s_mov_b32 s43, 0
    s_branch L_tail
L_fin:
    s_mov_b32 exec_lo, 0x000f000f
    s_mov_b32 exec_hi, 0x000f000f
    buffer_store_short v32, v10, s[60:63], 0 offen
L_end:
    s_endpgm
.section .rodata,"a"
.p2align 6
.amdhsa_kernel recurrent_scan__mha_block_cached__moe_arch_mod__decode_kernel
  .amdhsa_next_free_vgpr 256
  .amdhsa_next_free_sgpr 102
  .amdhsa_accum_offset 256
  .amdhsa_group_segment_fixed_size 0
  .amdhsa_kernarg_size 104
  .amdhsa_user_sgpr_count 2
  .amdhsa_user_sgpr_kernarg_segment_ptr 1
  .amdhsa_system_sgpr_workgroup_id_x 1
  .amdhsa_float_denorm_mode_32 3
.end_amdhsa_kernel
```
